```python
import torch

def _softmax(x, axis=-1):
    return torch.softmax(x, dim=axis)
def _gelu(x):
    return torch.nn.functional.gelu(x, approximate="tanh")
def _silu(x):
    return torch.nn.functional.silu(x)
def _sigmoid(x):
    return torch.sigmoid(x)
def _layernorm(x, axis=-1, eps=1e-5):
    m = x.mean(dim=axis, keepdim=True)
    v = x.var(dim=axis, keepdim=True, unbiased=False)
    return (x - m) / torch.sqrt(v + eps)
def _scatter_add(tgt, idx, src, axis=0):
    return tgt.clone().index_add_(axis, idx, src)
def _segment_sum(src, seg, n):
    out = torch.zeros((n,) + src.shape[1:], dtype=src.dtype)
    return out.index_add_(0, seg, src)
def _pad(x, pw):
    flat = tuple(v for pair in reversed(pw) for v in pair)
    return torch.nn.functional.pad(x, flat)

kernel_name = 'parallel_sum__spectral_fnet__dense_activation_squared_relu__prompt'

def setup_inputs():

    _w = (lambda a: (lambda t: t.to(torch.bfloat16) if t.is_floating_point() else t)(torch.as_tensor(a)))
    def _A_setup():
        B, S, D = 1, 2048, 512
        ns = torch.arange(S)[:, None] * torch.arange(S)[None, :]
        nd = torch.arange(D)[:, None] * torch.arange(D)[None, :]
        Ws_re = torch.cos(-2.0 * torch.pi * ns / S).to(float)
        Ws_im = torch.sin(-2.0 * torch.pi * ns / S).to(float)
        Wd_re = torch.cos(-2.0 * torch.pi * nd / D).to(float)
        Wd_im = torch.sin(-2.0 * torch.pi * nd / D).to(float)
        return {
            "x": _w((lambda *s: torch.randn(*s, dtype=torch.bfloat16) * 0.05)(B, S, D)),
            "dft_seq_re": _w(Ws_re),
            "dft_seq_im": _w(Ws_im),
            "dft_hid_re": _w(Wd_re),
            "dft_hid_im": _w(Wd_im),
        }
    _A_in = _A_setup()

    def _B_setup():
        B, S, D, F = 1, 2048, 512, 1792
        return {
            "x": _w((lambda *s: torch.randn(*s, dtype=torch.bfloat16) * 0.05)(B, S, D)),
            "w1": _w((lambda *s: torch.randn(*s, dtype=torch.bfloat16) * 0.2)(D, F)),
            "b1": _w((lambda *s: torch.randn(*s, dtype=torch.bfloat16) * 0.2)(F)),
            "w2": _w((lambda *s: torch.randn(*s, dtype=torch.bfloat16) * 0.2)(F, D)),
            "b2": _w((lambda *s: torch.randn(*s, dtype=torch.bfloat16) * 0.2)(D)),
        }
    _B_in = _B_setup()

    return {
        "A_x": _A_in["x"],
        "A_dft_seq_re": _A_in["dft_seq_re"],
        "A_dft_seq_im": _A_in["dft_seq_im"],
        "A_dft_hid_re": _A_in["dft_hid_re"],
        "A_dft_hid_im": _A_in["dft_hid_im"],
        "B_x": _B_in["x"],
        "B_w1": _B_in["w1"],
        "B_b1": _B_in["b1"],
        "B_w2": _B_in["w2"],
        "B_b2": _B_in["b2"],
    }

def reference(A_x, A_dft_seq_re, A_dft_seq_im, A_dft_hid_re, A_dft_hid_im, B_x, B_w1, B_b1, B_w2, B_b2):
    def _A_ref(x, dft_seq_re, dft_seq_im, dft_hid_re, dft_hid_im):
        a = torch.einsum("bsd,ed->bse", x, dft_hid_re)
        b = torch.einsum("bsd,ed->bse", x, dft_hid_im)
        y = torch.einsum("ts,bse->bte", dft_seq_re, a) - torch.einsum("ts,bse->bte", dft_seq_im, b)
        return y

    def _B_ref(x, w1, b1, w2, b2):
        h = torch.einsum("bsd,df->bsf", x, w1) + b1
        zero = torch.zeros_like(h)
        r = torch.where(h > zero, h, zero)
        h = r * r
        out = torch.einsum("bsf,fd->bsd", h, w2) + b2
        return out

    x = A_x
    xn = _layernorm(x, axis=-1)
    return x + _A_ref(xn, A_dft_seq_re, A_dft_seq_im, A_dft_hid_re, A_dft_hid_im) + _B_ref(xn, B_w1, B_b1, B_w2, B_b2)
```

```asm
; @launch kernel=gemm1_kernel grid=(256,1,1) block=(512,1,1) lds=157952
; @launch kernel=gemm2_kernel grid=(256,1,1) block=(512,1,1) lds=131072
.amdgcn_target "amdgcn-amd-amdhsa--gfx950"
.text
.globl gemm1_kernel
.p2align 8
.type gemm1_kernel,@function
gemm1_kernel:
    s_cmp_ge_u32 s2, 256
    s_cbranch_scc1 g1_done
    s_load_dwordx2 s[6:7], s[0:1], 96
    s_load_dwordx2 s[4:5], s[0:1], 56
    s_load_dwordx2 s[42:43], s[0:1], 0
    s_load_dwordx2 s[72:73], s[0:1], 24
    s_load_dwordx2 s[74:75], s[0:1], 32
    s_load_dwordx2 s[76:77], s[0:1], 48
    s_and_b32 s16, s2, 15
    s_lshr_b32 s17, s2, 4
    v_lshrrev_b32 v1, 6, v0
    v_and_b32 v2, 63, v0
    s_nop 0
    v_readfirstlane_b32 s18, v1
    s_waitcnt lgkmcnt(0)
    s_lshr_b32 s40, s18, 2
    s_and_b32 s18, s18, 3
    s_and_b32 s73, s73, 0xffff
    s_and_b32 s75, s75, 0xffff
    s_mov_b32 s8, s42
    s_mov_b32 s9, s43
    s_and_b32 s9, s9, 0xffff
    s_mov_b32 s10, 0x200000
    s_mov_b32 s11, 0x20000
    s_mov_b32 s44, s76
    s_mov_b32 s45, s77
    s_and_b32 s45, s45, 0xffff
    s_mov_b32 s46, 0x1c0000
    s_mov_b32 s47, 0x20000
    s_mov_b32 s14, 0x80000
    s_mov_b32 s15, 0x20000
    s_mov_b32 s12, s72
    s_mov_b32 s13, s73
    s_cmp_eq_u32 s40, 0
    s_cbranch_scc1 g1_compute
    v_lshrrev_b32 v3, 3, v2
    v_and_b32 v4, 7, v2
    v_lshrrev_b32 v5, 4, v2
    s_and_b32 s19, s18, 1
    s_lshl_b32 s19, s19, 2
    v_add_u32 v5, s19, v5
    v_xor_b32 v5, v4, v5
    v_lshlrev_b32 v5, 4, v5
    v_lshl_add_u32 v5, v3, 10, v5
    v_lshlrev_b32 v4, 4, v4
    v_lshl_add_u32 v6, v3, 10, v4
    s_lshl_b32 s20, s16, 7
    s_lshl_b32 s21, s18, 3
    s_add_u32 s22, s20, s21
    s_lshl_b32 s22, s22, 10
    v_add_u32 v10, s22, v5
    v_add_u32 v11, 0x8000, v10
    v_add_u32 v12, 0x10000, v10
    v_add_u32 v13, 0x18000, v10
    s_lshl_b32 s21, s18, 5
    s_add_u32 s22, s20, s21
    s_lshl_b32 s22, s22, 10
    v_add_u32 v6, s22, v6
    s_lshl_b32 s24, s18, 10
    s_mul_i32 s25, s17, 176
    s_mov_b32 s33, 0x3f803f80
    s_cmp_lt_u32 s17, 5
    s_cbranch_scc1 g1_ld_11
    s_cmp_eq_u32 s17, 5
    s_cbranch_scc1 g1_ld_9
    s_branch g1_ld_0
g1_ld_11:
    s_add_u32 s26, s18, 0
    s_mov_b32 s90, s26
    s_lshl_b32 s80, s26, 10
    s_lshl_b32 s27, s26, 3
    s_add_u32 s27, s27, s25
    s_cmp_lt_u32 s27, 512
    s_cselect_b32 s60, s72, s74
    s_cselect_b32 s61, s73, s75
    s_and_b32 s27, s27, 511
    s_lshl_b32 s27, s27, 10
    v_add_u32 v14, s27, v5
    s_add_u32 s26, s18, 4
    s_mov_b32 s90, s26
    s_lshl_b32 s81, s26, 10
    s_lshl_b32 s27, s26, 3
    s_add_u32 s27, s27, s25
    s_cmp_lt_u32 s27, 512
    s_cselect_b32 s62, s72, s74
    s_cselect_b32 s63, s73, s75
    s_and_b32 s27, s27, 511
    s_lshl_b32 s27, s27, 10
    v_add_u32 v15, s27, v5
    s_add_u32 s26, s18, 8
    s_mov_b32 s90, s26
    s_lshl_b32 s82, s26, 10
    s_lshl_b32 s27, s26, 3
    s_add_u32 s27, s27, s25
    s_cmp_lt_u32 s27, 512
    s_cselect_b32 s64, s72, s74
    s_cselect_b32 s65, s73, s75
    s_and_b32 s27, s27, 511
    s_lshl_b32 s27, s27, 10
    v_add_u32 v16, s27, v5
    s_add_u32 s26, s18, 12
    s_mov_b32 s90, s26
    s_lshl_b32 s83, s26, 10
    s_lshl_b32 s27, s26, 3
    s_add_u32 s27, s27, s25
    s_cmp_lt_u32 s27, 512
    s_cselect_b32 s66, s72, s74
    s_cselect_b32 s67, s73, s75
    s_and_b32 s27, s27, 511
    s_lshl_b32 s27, s27, 10
    v_add_u32 v17, s27, v5
    s_add_u32 s26, s18, 16
    s_mov_b32 s90, s26
    s_lshl_b32 s84, s26, 10
    s_lshl_b32 s27, s26, 3
    s_add_u32 s27, s27, s25
    s_cmp_lt_u32 s27, 512
    s_cselect_b32 s68, s72, s74
    s_cselect_b32 s69, s73, s75
    s_and_b32 s27, s27, 511
    s_lshl_b32 s27, s27, 10
    v_add_u32 v18, s27, v5
    s_add_u32 s26, s18, 20
    s_cmp_lt_u32 s26, 22
    s_cselect_b32 s26, s26, s90
    s_mov_b32 s90, s26
    s_lshl_b32 s85, s26, 10
    s_lshl_b32 s27, s26, 3
    s_add_u32 s27, s27, s25
    s_cmp_lt_u32 s27, 512
    s_cselect_b32 s70, s72, s74
    s_cselect_b32 s71, s73, s75
    s_and_b32 s27, s27, 511
    s_lshl_b32 s27, s27, 10
    v_add_u32 v19, s27, v5
    s_mov_b32 s29, 0
    s_mov_b32 s28, 0
    s_add_u32 s30, s24, 0
    s_add_u32 m0, s30, 0
    s_nop 0
    buffer_load_dwordx4 v10, s[8:11], s29 offen lds
    s_add_u32 m0, s30, 4096
    s_nop 0
    buffer_load_dwordx4 v11, s[8:11], s29 offen lds
    s_add_u32 m0, s30, 8192
    s_nop 0
    buffer_load_dwordx4 v12, s[8:11], s29 offen lds
    s_add_u32 m0, s30, 12288
    s_nop 0
    buffer_load_dwordx4 v13, s[8:11], s29 offen lds
    s_mov_b32 s12, s60
    s_mov_b32 s13, s61
    s_add_u32 m0, s80, 16384
    s_nop 0
    buffer_load_dwordx4 v14, s[12:15], s29 offen lds
    s_mov_b32 s12, s62
    s_mov_b32 s13, s63
    s_add_u32 m0, s81, 16384
    s_nop 0
    buffer_load_dwordx4 v15, s[12:15], s29 offen lds
    s_mov_b32 s12, s64
    s_mov_b32 s13, s65
    s_add_u32 m0, s82, 16384
    s_nop 0
    buffer_load_dwordx4 v16, s[12:15], s29 offen lds
    s_mov_b32 s12, s66
    s_mov_b32 s13, s67
    s_add_u32 m0, s83, 16384
    s_nop 0
    buffer_load_dwordx4 v17, s[12:15], s29 offen lds
    s_mov_b32 s12, s68
    s_mov_b32 s13, s69
    s_add_u32 m0, s84, 16384
    s_nop 0
    buffer_load_dwordx4 v18, s[12:15], s29 offen lds
    s_mov_b32 s12, s70
    s_mov_b32 s13, s71
    s_add_u32 m0, s85, 16384
    s_nop 0
    buffer_load_dwordx4 v19, s[12:15], s29 offen lds
    s_mov_b32 s29, 128
    s_mov_b32 s28, 229376
    s_add_u32 s30, s24, 38912
    s_add_u32 m0, s30, 0
    s_nop 0
    buffer_load_dwordx4 v10, s[8:11], s29 offen lds
    s_add_u32 m0, s30, 4096
    s_nop 0
    buffer_load_dwordx4 v11, s[8:11], s29 offen lds
    s_add_u32 m0, s30, 8192
    s_nop 0
    buffer_load_dwordx4 v12, s[8:11], s29 offen lds
    s_add_u32 m0, s30, 12288
    s_nop 0
    buffer_load_dwordx4 v13, s[8:11], s29 offen lds
    s_mov_b32 s12, s60
    s_mov_b32 s13, s61
    s_add_u32 m0, s80, 55296
    s_nop 0
    buffer_load_dwordx4 v14, s[12:15], s29 offen lds
    s_mov_b32 s12, s62
    s_mov_b32 s13, s63
    s_add_u32 m0, s81, 55296
    s_nop 0
    buffer_load_dwordx4 v15, s[12:15], s29 offen lds
    s_mov_b32 s12, s64
    s_mov_b32 s13, s65
    s_add_u32 m0, s82, 55296
    s_nop 0
    buffer_load_dwordx4 v16, s[12:15], s29 offen lds
    s_mov_b32 s12, s66
    s_mov_b32 s13, s67
    s_add_u32 m0, s83, 55296
    s_nop 0
    buffer_load_dwordx4 v17, s[12:15], s29 offen lds
    s_mov_b32 s12, s68
    s_mov_b32 s13, s69
    s_add_u32 m0, s84, 55296
    s_nop 0
    buffer_load_dwordx4 v18, s[12:15], s29 offen lds
    s_mov_b32 s12, s70
    s_mov_b32 s13, s71
    s_add_u32 m0, s85, 55296
    s_nop 0
    buffer_load_dwordx4 v19, s[12:15], s29 offen lds
    s_mov_b32 s29, 256
    s_mov_b32 s28, 458752
    s_add_u32 s30, s24, 77824
    s_add_u32 m0, s30, 0
    s_nop 0
    buffer_load_dwordx4 v10, s[8:11], s29 offen lds
    s_add_u32 m0, s30, 4096
    s_nop 0
    buffer_load_dwordx4 v11, s[8:11], s29 offen lds
    s_add_u32 m0, s30, 8192
    s_nop 0
    buffer_load_dwordx4 v12, s[8:11], s29 offen lds
    s_add_u32 m0, s30, 12288
    s_nop 0
    buffer_load_dwordx4 v13, s[8:11], s29 offen lds
    s_mov_b32 s12, s60
    s_mov_b32 s13, s61
    s_add_u32 m0, s80, 94208
    s_nop 0
    buffer_load_dwordx4 v14, s[12:15], s29 offen lds
    s_mov_b32 s12, s62
    s_mov_b32 s13, s63
    s_add_u32 m0, s81, 94208
    s_nop 0
    buffer_load_dwordx4 v15, s[12:15], s29 offen lds
    s_mov_b32 s12, s64
    s_mov_b32 s13, s65
    s_add_u32 m0, s82, 94208
    s_nop 0
    buffer_load_dwordx4 v16, s[12:15], s29 offen lds
    s_mov_b32 s12, s66
    s_mov_b32 s13, s67
    s_add_u32 m0, s83, 94208
    s_nop 0
    buffer_load_dwordx4 v17, s[12:15], s29 offen lds
    s_mov_b32 s12, s68
    s_mov_b32 s13, s69
    s_add_u32 m0, s84, 94208
    s_nop 0
    buffer_load_dwordx4 v18, s[12:15], s29 offen lds
    s_mov_b32 s12, s70
    s_mov_b32 s13, s71
    s_add_u32 m0, s85, 94208
    s_nop 0
    buffer_load_dwordx4 v19, s[12:15], s29 offen lds
    v_mov_b32 v170, 0
    v_mov_b32 v171, 0
    v_mov_b32 v172, 0
    v_mov_b32 v173, 0
    v_mov_b32 v174, 0
    v_mov_b32 v175, 0
    v_mov_b32 v176, 0
    v_mov_b32 v177, 0
    s_lshl_b32 s31, s18, 12
    v_lshlrev_b32 v6, 4, v2
    v_add_u32 v6, s31, v6
    s_load_dwordx2 s[34:35], s[0:1], 64
    s_lshl_b32 s31, s18, 6
    v_add_u32 v24, s31, v2
    v_lshrrev_b32 v25, 3, v24
    v_and_b32 v26, 7, v24
    s_min_u32 s38, s2, 223
    s_lshr_b32 s36, s38, 3
    s_and_b32 s37, s38, 7
    s_waitcnt lgkmcnt(0)
    s_mov_b32 s48, s34
    s_mov_b32 s49, s35
    s_and_b32 s49, s49, 0xffff
    s_mov_b32 s50, 0x1c0000
    s_mov_b32 s51, 0x20000
    s_add_u32 s52, s6, 0x500000
    s_addc_u32 s53, s7, 0
    s_and_b32 s53, s53, 0xffff
    s_mov_b32 s54, 0x200000
    s_mov_b32 s55, 0x20000
    s_lshl_b32 s38, s36, 6
    s_lshl_b32 s39, s37, 7
    v_add_u32 v27, s38, v25
    v_lshlrev_b32 v27, 10, v27
    v_lshl_add_u32 v27, v26, 4, v27
    v_add_u32 v27, s39, v27
    s_mov_b32 s31, 0x8000
    buffer_load_dwordx4 v[160:163], v27, s[48:51], 0 offen
    buffer_load_dwordx4 v[164:167], v27, s[48:51], s31 offen
    s_waitcnt vmcnt(22)
    s_barrier
    s_waitcnt vmcnt(12)
    s_barrier
    s_add_u32 s56, s6, 0x1f00000
    s_addc_u32 s57, s7, 0
    s_and_b32 s57, s57, 0xffff
    s_mov_b32 s58, 0x8000
    s_mov_b32 s59, 0x20000
    s_lshl_b32 s31, s2, 7
    v_mov_b32 v28, s31
    v_mov_b32 v32, 0
    v_mov_b32 v33, 0
    v_mov_b32 v34, 0
    v_mov_b32 v35, 0
    buffer_store_dwordx4 v[32:35], v28, s[56:59], 0 offen
    s_mov_b32 s29, 384
    s_mov_b32 s28, 688128
    s_add_u32 s30, s24, 116736
    s_add_u32 m0, s30, 0
    s_nop 0
    buffer_load_dwordx4 v10, s[8:11], s29 offen lds
    s_add_u32 m0, s30, 4096
    s_nop 0
    buffer_load_dwordx4 v11, s[8:11], s29 offen lds
    s_add_u32 m0, s30, 8192
    s_nop 0
    buffer_load_dwordx4 v12, s[8:11], s29 offen lds
    s_add_u32 m0, s30, 12288
    s_nop 0
    buffer_load_dwordx4 v13, s[8:11], s29 offen lds
    s_mov_b32 s12, s60
    s_mov_b32 s13, s61
    s_add_u32 m0, s80, 133120
    s_nop 0
    buffer_load_dwordx4 v14, s[12:15], s29 offen lds
    s_mov_b32 s12, s62
    s_mov_b32 s13, s63
    s_add_u32 m0, s81, 133120
    s_nop 0
    buffer_load_dwordx4 v15, s[12:15], s29 offen lds
    s_mov_b32 s12, s64
    s_mov_b32 s13, s65
    s_add_u32 m0, s82, 133120
    s_nop 0
    buffer_load_dwordx4 v16, s[12:15], s29 offen lds
    s_mov_b32 s12, s66
    s_mov_b32 s13, s67
    s_add_u32 m0, s83, 133120
    s_nop 0
    buffer_load_dwordx4 v17, s[12:15], s29 offen lds
    s_mov_b32 s12, s68
    s_mov_b32 s13, s69
    s_add_u32 m0, s84, 133120
    s_nop 0
    buffer_load_dwordx4 v18, s[12:15], s29 offen lds
    s_mov_b32 s12, s70
    s_mov_b32 s13, s71
    s_add_u32 m0, s85, 133120
    s_nop 0
    buffer_load_dwordx4 v19, s[12:15], s29 offen lds
    s_waitcnt vmcnt(13)
    s_barrier
    s_mov_b32 s29, 512
    s_mov_b32 s28, 917504
    s_add_u32 s30, s24, 0
    s_add_u32 m0, s30, 0
    s_nop 0
    buffer_load_dwordx4 v10, s[8:11], s29 offen lds
    s_add_u32 m0, s30, 4096
    s_nop 0
    buffer_load_dwordx4 v11, s[8:11], s29 offen lds
    s_add_u32 m0, s30, 8192
    s_nop 0
    buffer_load_dwordx4 v12, s[8:11], s29 offen lds
    s_add_u32 m0, s30, 12288
    s_nop 0
    buffer_load_dwordx4 v13, s[8:11], s29 offen lds
    s_mov_b32 s12, s60
    s_mov_b32 s13, s61
    s_add_u32 m0, s80, 16384
    s_nop 0
    buffer_load_dwordx4 v14, s[12:15], s29 offen lds
    s_mov_b32 s12, s62
    s_mov_b32 s13, s63
    s_add_u32 m0, s81, 16384
    s_nop 0
    buffer_load_dwordx4 v15, s[12:15], s29 offen lds
    s_mov_b32 s12, s64
    s_mov_b32 s13, s65
    s_add_u32 m0, s82, 16384
    s_nop 0
    buffer_load_dwordx4 v16, s[12:15], s29 offen lds
    s_mov_b32 s12, s66
    s_mov_b32 s13, s67
    s_add_u32 m0, s83, 16384
    s_nop 0
    buffer_load_dwordx4 v17, s[12:15], s29 offen lds
    s_mov_b32 s12, s68
    s_mov_b32 s13, s69
    s_add_u32 m0, s84, 16384
    s_nop 0
    buffer_load_dwordx4 v18, s[12:15], s29 offen lds
    s_mov_b32 s12, s70
    s_mov_b32 s13, s71
    s_add_u32 m0, s85, 16384
    s_nop 0
    buffer_load_dwordx4 v19, s[12:15], s29 offen lds
    s_waitcnt vmcnt(10)
    s_barrier
    s_mov_b32 s29, 640
    s_mov_b32 s28, 1146880
    s_add_u32 s30, s24, 38912
    s_add_u32 m0, s30, 0
    s_nop 0
    buffer_load_dwordx4 v10, s[8:11], s29 offen lds
    s_add_u32 m0, s30, 4096
    s_nop 0
    buffer_load_dwordx4 v11, s[8:11], s29 offen lds
    s_add_u32 m0, s30, 8192
    s_nop 0
    buffer_load_dwordx4 v12, s[8:11], s29 offen lds
    s_add_u32 m0, s30, 12288
    s_nop 0
    buffer_load_dwordx4 v13, s[8:11], s29 offen lds
    s_mov_b32 s12, s60
    s_mov_b32 s13, s61
    s_add_u32 m0, s80, 55296
    s_nop 0
    buffer_load_dwordx4 v14, s[12:15], s29 offen lds
    s_mov_b32 s12, s62
    s_mov_b32 s13, s63
    s_add_u32 m0, s81, 55296
    s_nop 0
    buffer_load_dwordx4 v15, s[12:15], s29 offen lds
    s_mov_b32 s12, s64
    s_mov_b32 s13, s65
    s_add_u32 m0, s82, 55296
    s_nop 0
    buffer_load_dwordx4 v16, s[12:15], s29 offen lds
    s_mov_b32 s12, s66
    s_mov_b32 s13, s67
    s_add_u32 m0, s83, 55296
    s_nop 0
    buffer_load_dwordx4 v17, s[12:15], s29 offen lds
    s_mov_b32 s12, s68
    s_mov_b32 s13, s69
    s_add_u32 m0, s84, 55296
    s_nop 0
    buffer_load_dwordx4 v18, s[12:15], s29 offen lds
    s_mov_b32 s12, s70
    s_mov_b32 s13, s71
    s_add_u32 m0, s85, 55296
    s_nop 0
    buffer_load_dwordx4 v19, s[12:15], s29 offen lds
    s_waitcnt vmcnt(10)
    s_barrier
    s_mov_b32 s29, 768
    s_mov_b32 s28, 1376256
    s_add_u32 s30, s24, 77824
    s_add_u32 m0, s30, 0
    s_nop 0
    buffer_load_dwordx4 v10, s[8:11], s29 offen lds
    s_add_u32 m0, s30, 4096
    s_nop 0
    buffer_load_dwordx4 v11, s[8:11], s29 offen lds
    s_add_u32 m0, s30, 8192
    s_nop 0
    buffer_load_dwordx4 v12, s[8:11], s29 offen lds
    s_add_u32 m0, s30, 12288
    s_nop 0
    buffer_load_dwordx4 v13, s[8:11], s29 offen lds
    s_mov_b32 s12, s60
    s_mov_b32 s13, s61
    s_add_u32 m0, s80, 94208
    s_nop 0
    buffer_load_dwordx4 v14, s[12:15], s29 offen lds
    s_mov_b32 s12, s62
    s_mov_b32 s13, s63
    s_add_u32 m0, s81, 94208
    s_nop 0
    buffer_load_dwordx4 v15, s[12:15], s29 offen lds
    s_mov_b32 s12, s64
    s_mov_b32 s13, s65
    s_add_u32 m0, s82, 94208
    s_nop 0
    buffer_load_dwordx4 v16, s[12:15], s29 offen lds
    s_mov_b32 s12, s66
    s_mov_b32 s13, s67
    s_add_u32 m0, s83, 94208
    s_nop 0
    buffer_load_dwordx4 v17, s[12:15], s29 offen lds
    s_mov_b32 s12, s68
    s_mov_b32 s13, s69
    s_add_u32 m0, s84, 94208
    s_nop 0
    buffer_load_dwordx4 v18, s[12:15], s29 offen lds
    s_mov_b32 s12, s70
    s_mov_b32 s13, s71
    s_add_u32 m0, s85, 94208
    s_nop 0
    buffer_load_dwordx4 v19, s[12:15], s29 offen lds
    s_waitcnt vmcnt(10)
    s_barrier
    s_mov_b32 s29, 896
    s_mov_b32 s28, 1605632
    s_add_u32 s30, s24, 116736
    s_add_u32 m0, s30, 0
    s_nop 0
    buffer_load_dwordx4 v10, s[8:11], s29 offen lds
    s_add_u32 m0, s30, 4096
    s_nop 0
    buffer_load_dwordx4 v11, s[8:11], s29 offen lds
    s_add_u32 m0, s30, 8192
    s_nop 0
    buffer_load_dwordx4 v12, s[8:11], s29 offen lds
    s_add_u32 m0, s30, 12288
    s_nop 0
    buffer_load_dwordx4 v13, s[8:11], s29 offen lds
    s_mov_b32 s12, s60
    s_mov_b32 s13, s61
    s_add_u32 m0, s80, 133120
    s_nop 0
    buffer_load_dwordx4 v14, s[12:15], s29 offen lds
    s_mov_b32 s12, s62
    s_mov_b32 s13, s63
    s_add_u32 m0, s81, 133120
    s_nop 0
    buffer_load_dwordx4 v15, s[12:15], s29 offen lds
    s_mov_b32 s12, s64
    s_mov_b32 s13, s65
    s_add_u32 m0, s82, 133120
    s_nop 0
    buffer_load_dwordx4 v16, s[12:15], s29 offen lds
    s_mov_b32 s12, s66
    s_mov_b32 s13, s67
    s_add_u32 m0, s83, 133120
    s_nop 0
    buffer_load_dwordx4 v17, s[12:15], s29 offen lds
    s_mov_b32 s12, s68
    s_mov_b32 s13, s69
    s_add_u32 m0, s84, 133120
    s_nop 0
    buffer_load_dwordx4 v18, s[12:15], s29 offen lds
    s_mov_b32 s12, s70
    s_mov_b32 s13, s71
    s_add_u32 m0, s85, 133120
    s_nop 0
    buffer_load_dwordx4 v19, s[12:15], s29 offen lds
    s_load_dwordx2 s[34:35], s[0:1], 8
    s_load_dwordx2 s[56:57], s[0:1], 16
    s_lshl_b32 s31, s2, 2
    s_add_u32 s31, s31, s18
    s_and_b32 s38, s31, 511
    s_lshl_b32 s38, s38, 14
    v_lshlrev_b32 v29, 7, v2
    v_add_u32 v29, s38, v29
    s_waitcnt lgkmcnt(0)
    s_cmp_ge_u32 s31, 512
    s_cselect_b32 s34, s56, s34
    s_cselect_b32 s35, s57, s35
    s_mov_b32 s56, s34
    s_mov_b32 s57, s35
    s_and_b32 s57, s57, 0xffff
    s_mov_b32 s58, 0x800000
    s_mov_b32 s59, 0x20000
    s_mov_b32 s31, 0
    buffer_load_dword v64, v29, s[56:59], s31 offen
    s_mov_b32 s31, 8192
    buffer_load_dword v65, v29, s[56:59], s31 offen
    s_waitcnt vmcnt(12)
    s_barrier
    v_mul_u32_u24 v28, 8*144, v26
    v_lshl_add_u32 v28, v25, 1, v28
    s_waitcnt vmcnt(53)
    ds_write_b16 v28, v160 offset:0
    ds_write_b16_d16_hi v28, v160 offset:144
    ds_write_b16 v28, v161 offset:288
    ds_write_b16_d16_hi v28, v161 offset:432
    ds_write_b16 v28, v162 offset:576
    ds_write_b16_d16_hi v28, v162 offset:720
    ds_write_b16 v28, v163 offset:864
    ds_write_b16_d16_hi v28, v163 offset:1008
    ds_write_b16 v28, v164 offset:64
    ds_write_b16_d16_hi v28, v164 offset:208
    ds_write_b16 v28, v165 offset:352
    ds_write_b16_d16_hi v28, v165 offset:496
    ds_write_b16 v28, v166 offset:640
    ds_write_b16_d16_hi v28, v166 offset:784
    ds_write_b16 v28, v167 offset:928
    ds_write_b16_d16_hi v28, v167 offset:1072
    s_waitcnt lgkmcnt(0)
    s_waitcnt vmcnt(2)
    s_barrier
    s_cmp_ge_u32 s2, 224
    s_cbranch_scc1 g1_tr2_skip_11
    v_mul_u32_u24 v28, 144, v25
    v_lshl_add_u32 v28, v26, 4, v28
    ds_read_b128 v[160:163], v28
    ds_read_b128 v[164:167], v28 offset:4608
    s_lshl_b32 s38, s37, 6
    s_lshl_b32 s39, s36, 7
    v_add_u32 v27, s38, v25
    v_lshlrev_b32 v27, 12, v27
    v_lshl_add_u32 v27, v26, 4, v27
    v_add_u32 v27, s39, v27
    s_mov_b32 s31, 0x20000
    s_waitcnt lgkmcnt(0)
    buffer_store_dwordx4 v[160:163], v27, s[52:55], 0 offen
    buffer_store_dwordx4 v[164:167], v27, s[52:55], s31 offen
g1_tr2_skip_11:
    s_barrier
    s_endpgm
g1_ld_9:
    s_add_u32 s26, s18, 0
    s_mov_b32 s90, s26
    s_lshl_b32 s80, s26, 10
    s_lshl_b32 s27, s26, 3
    s_add_u32 s27, s27, s25
    s_cmp_lt_u32 s27, 512
    s_cselect_b32 s60, s72, s74
    s_cselect_b32 s61, s73, s75
    s_and_b32 s27, s27, 511
    s_lshl_b32 s27, s27, 10
    v_add_u32 v14, s27, v5
    s_add_u32 s26, s18, 4
    s_mov_b32 s90, s26
    s_lshl_b32 s81, s26, 10
    s_lshl_b32 s27, s26, 3
    s_add_u32 s27, s27, s25
    s_cmp_lt_u32 s27, 512
    s_cselect_b32 s62, s72, s74
    s_cselect_b32 s63, s73, s75
    s_and_b32 s27, s27, 511
    s_lshl_b32 s27, s27, 10
    v_add_u32 v15, s27, v5
    s_add_u32 s26, s18, 8
    s_mov_b32 s90, s26
    s_lshl_b32 s82, s26, 10
    s_lshl_b32 s27, s26, 3
    s_add_u32 s27, s27, s25
    s_cmp_lt_u32 s27, 512
    s_cselect_b32 s64, s72, s74
    s_cselect_b32 s65, s73, s75
    s_and_b32 s27, s27, 511
    s_lshl_b32 s27, s27, 10
    v_add_u32 v16, s27, v5
    s_add_u32 s26, s18, 12
    s_mov_b32 s90, s26
    s_lshl_b32 s83, s26, 10
    s_lshl_b32 s27, s26, 3
    s_add_u32 s27, s27, s25
    s_cmp_lt_u32 s27, 512
    s_cselect_b32 s66, s72, s74
    s_cselect_b32 s67, s73, s75
    s_and_b32 s27, s27, 511
    s_lshl_b32 s27, s27, 10
    v_add_u32 v17, s27, v5
    s_add_u32 s26, s18, 16
    s_cmp_lt_u32 s26, 18
    s_cselect_b32 s26, s26, s90
    s_mov_b32 s90, s26
    s_lshl_b32 s84, s26, 10
    s_lshl_b32 s27, s26, 3
    s_add_u32 s27, s27, s25
    s_cmp_lt_u32 s27, 512
    s_cselect_b32 s68, s72, s74
    s_cselect_b32 s69, s73, s75
    s_and_b32 s27, s27, 511
    s_lshl_b32 s27, s27, 10
    v_add_u32 v18, s27, v5
    s_add_u32 s26, s18, 0
    s_mov_b32 s90, s26
    s_lshl_b32 s27, s26, 10
    s_add_u32 s85, s27, 18432
    s_lshl_b32 s27, s26, 6
    v_add_u32 v7, s27, v2
    v_lshrrev_b32 v8, 2, v7
    v_and_b32 v9, 3, v7
    v_mul_u32_u24 v8, 3584, v8
    v_lshl_add_u32 v19, v9, 4, v8
    s_add_u32 s27, s25, 144
    s_sub_u32 s27, s27, 1024
    s_lshl_b32 s27, s27, 1
    v_add_u32 v19, s27, v19
    s_mov_b32 s29, 0
    s_mov_b32 s28, 0
    s_add_u32 s30, s24, 0
    s_add_u32 m0, s30, 0
    s_nop 0
    buffer_load_dwordx4 v10, s[8:11], s29 offen lds
    s_add_u32 m0, s30, 4096
    s_nop 0
    buffer_load_dwordx4 v11, s[8:11], s29 offen lds
    s_add_u32 m0, s30, 8192
    s_nop 0
    buffer_load_dwordx4 v12, s[8:11], s29 offen lds
    s_add_u32 m0, s30, 12288
    s_nop 0
    buffer_load_dwordx4 v13, s[8:11], s29 offen lds
    s_mov_b32 s12, s60
    s_mov_b32 s13, s61
    s_add_u32 m0, s80, 16384
    s_nop 0
    buffer_load_dwordx4 v14, s[12:15], s29 offen lds
    s_mov_b32 s12, s62
    s_mov_b32 s13, s63
    s_add_u32 m0, s81, 16384
    s_nop 0
    buffer_load_dwordx4 v15, s[12:15], s29 offen lds
    s_mov_b32 s12, s64
    s_mov_b32 s13, s65
    s_add_u32 m0, s82, 16384
    s_nop 0
    buffer_load_dwordx4 v16, s[12:15], s29 offen lds
    s_mov_b32 s12, s66
    s_mov_b32 s13, s67
    s_add_u32 m0, s83, 16384
    s_nop 0
    buffer_load_dwordx4 v17, s[12:15], s29 offen lds
    s_mov_b32 s12, s68
    s_mov_b32 s13, s69
    s_add_u32 m0, s84, 16384
    s_nop 0
    buffer_load_dwordx4 v18, s[12:15], s29 offen lds
    s_add_u32 m0, s85, 16384
    s_nop 0
    buffer_load_dwordx4 v19, s[44:47], s28 offen lds
    s_mov_b32 s29, 128
    s_mov_b32 s28, 229376
    s_add_u32 s30, s24, 38912
    s_add_u32 m0, s30, 0
    s_nop 0
    buffer_load_dwordx4 v10, s[8:11], s29 offen lds
    s_add_u32 m0, s30, 4096
    s_nop 0
    buffer_load_dwordx4 v11, s[8:11], s29 offen lds
    s_add_u32 m0, s30, 8192
    s_nop 0
    buffer_load_dwordx4 v12, s[8:11], s29 offen lds
    s_add_u32 m0, s30, 12288
    s_nop 0
    buffer_load_dwordx4 v13, s[8:11], s29 offen lds
    s_mov_b32 s12, s60
    s_mov_b32 s13, s61
    s_add_u32 m0, s80, 55296
    s_nop 0
    buffer_load_dwordx4 v14, s[12:15], s29 offen lds
    s_mov_b32 s12, s62
    s_mov_b32 s13, s63
    s_add_u32 m0, s81, 55296
    s_nop 0
    buffer_load_dwordx4 v15, s[12:15], s29 offen lds
    s_mov_b32 s12, s64
    s_mov_b32 s13, s65
    s_add_u32 m0, s82, 55296
    s_nop 0
    buffer_load_dwordx4 v16, s[12:15], s29 offen lds
    s_mov_b32 s12, s66
    s_mov_b32 s13, s67
    s_add_u32 m0, s83, 55296
    s_nop 0
    buffer_load_dwordx4 v17, s[12:15], s29 offen lds
    s_mov_b32 s12, s68
    s_mov_b32 s13, s69
    s_add_u32 m0, s84, 55296
    s_nop 0
    buffer_load_dwordx4 v18, s[12:15], s29 offen lds
    s_add_u32 m0, s85, 55296
    s_nop 0
    buffer_load_dwordx4 v19, s[44:47], s28 offen lds
    s_mov_b32 s29, 256
    s_mov_b32 s28, 458752
    s_add_u32 s30, s24, 77824
    s_add_u32 m0, s30, 0
    s_nop 0
    buffer_load_dwordx4 v10, s[8:11], s29 offen lds
    s_add_u32 m0, s30, 4096
    s_nop 0
    buffer_load_dwordx4 v11, s[8:11], s29 offen lds
    s_add_u32 m0, s30, 8192
    s_nop 0
    buffer_load_dwordx4 v12, s[8:11], s29 offen lds
    s_add_u32 m0, s30, 12288
    s_nop 0
    buffer_load_dwordx4 v13, s[8:11], s29 offen lds
    s_mov_b32 s12, s60
    s_mov_b32 s13, s61
    s_add_u32 m0, s80, 94208
    s_nop 0
    buffer_load_dwordx4 v14, s[12:15], s29 offen lds
    s_mov_b32 s12, s62
    s_mov_b32 s13, s63
    s_add_u32 m0, s81, 94208
    s_nop 0
    buffer_load_dwordx4 v15, s[12:15], s29 offen lds
    s_mov_b32 s12, s64
    s_mov_b32 s13, s65
    s_add_u32 m0, s82, 94208
    s_nop 0
    buffer_load_dwordx4 v16, s[12:15], s29 offen lds
    s_mov_b32 s12, s66
    s_mov_b32 s13, s67
    s_add_u32 m0, s83, 94208
    s_nop 0
    buffer_load_dwordx4 v17, s[12:15], s29 offen lds
    s_mov_b32 s12, s68
    s_mov_b32 s13, s69
    s_add_u32 m0, s84, 94208
    s_nop 0
    buffer_load_dwordx4 v18, s[12:15], s29 offen lds
    s_add_u32 m0, s85, 94208
    s_nop 0
    buffer_load_dwordx4 v19, s[44:47], s28 offen lds
    v_mov_b32 v170, 0
    v_mov_b32 v171, 0
    v_mov_b32 v172, 0
    v_mov_b32 v173, 0
    v_mov_b32 v174, 0
    v_mov_b32 v175, 0
    v_mov_b32 v176, 0
    v_mov_b32 v177, 0
    s_lshl_b32 s31, s18, 12
    v_lshlrev_b32 v6, 4, v2
    v_add_u32 v6, s31, v6
    s_load_dwordx2 s[34:35], s[0:1], 64
    s_lshl_b32 s31, s18, 6
    v_add_u32 v24, s31, v2
    v_lshrrev_b32 v25, 3, v24
    v_and_b32 v26, 7, v24
    s_min_u32 s38, s2, 223
    s_lshr_b32 s36, s38, 3
    s_and_b32 s37, s38, 7
    s_waitcnt lgkmcnt(0)
    s_mov_b32 s48, s34
    s_mov_b32 s49, s35
    s_and_b32 s49, s49, 0xffff
    s_mov_b32 s50, 0x1c0000
    s_mov_b32 s51, 0x20000
    s_add_u32 s52, s6, 0x500000
    s_addc_u32 s53, s7, 0
    s_and_b32 s53, s53, 0xffff
    s_mov_b32 s54, 0x200000
    s_mov_b32 s55, 0x20000
    s_lshl_b32 s38, s36, 6
    s_lshl_b32 s39, s37, 7
    v_add_u32 v27, s38, v25
    v_lshlrev_b32 v27, 10, v27
    v_lshl_add_u32 v27, v26, 4, v27
    v_add_u32 v27, s39, v27
    s_mov_b32 s31, 0x8000
    buffer_load_dwordx4 v[160:163], v27, s[48:51], 0 offen
    buffer_load_dwordx4 v[164:167], v27, s[48:51], s31 offen
    s_waitcnt vmcnt(22)
    s_barrier
    s_waitcnt vmcnt(12)
    s_barrier
    s_add_u32 s56, s6, 0x1f00000
    s_addc_u32 s57, s7, 0
    s_and_b32 s57, s57, 0xffff
    s_mov_b32 s58, 0x8000
    s_mov_b32 s59, 0x20000
    s_lshl_b32 s31, s2, 7
    v_mov_b32 v28, s31
    v_mov_b32 v32, 0
    v_mov_b32 v33, 0
    v_mov_b32 v34, 0
    v_mov_b32 v35, 0
    buffer_store_dwordx4 v[32:35], v28, s[56:59], 0 offen
    s_mov_b32 s29, 384
    s_mov_b32 s28, 688128
    s_add_u32 s30, s24, 116736
    s_add_u32 m0, s30, 0
    s_nop 0
    buffer_load_dwordx4 v10, s[8:11], s29 offen lds
    s_add_u32 m0, s30, 4096
    s_nop 0
    buffer_load_dwordx4 v11, s[8:11], s29 offen lds
    s_add_u32 m0, s30, 8192
    s_nop 0
    buffer_load_dwordx4 v12, s[8:11], s29 offen lds
    s_add_u32 m0, s30, 12288
    s_nop 0
    buffer_load_dwordx4 v13, s[8:11], s29 offen lds
    s_mov_b32 s12, s60
    s_mov_b32 s13, s61
    s_add_u32 m0, s80, 133120
    s_nop 0
    buffer_load_dwordx4 v14, s[12:15], s29 offen lds
    s_mov_b32 s12, s62
    s_mov_b32 s13, s63
    s_add_u32 m0, s81, 133120
    s_nop 0
    buffer_load_dwordx4 v15, s[12:15], s29 offen lds
    s_mov_b32 s12, s64
    s_mov_b32 s13, s65
    s_add_u32 m0, s82, 133120
    s_nop 0
    buffer_load_dwordx4 v16, s[12:15], s29 offen lds
    s_mov_b32 s12, s66
    s_mov_b32 s13, s67
    s_add_u32 m0, s83, 133120
    s_nop 0
    buffer_load_dwordx4 v17, s[12:15], s29 offen lds
    s_mov_b32 s12, s68
    s_mov_b32 s13, s69
    s_add_u32 m0, s84, 133120
    s_nop 0
    buffer_load_dwordx4 v18, s[12:15], s29 offen lds
    s_add_u32 m0, s85, 133120
    s_nop 0
    buffer_load_dwordx4 v19, s[44:47], s28 offen lds
    s_waitcnt vmcnt(13)
    s_barrier
    s_mov_b32 s29, 512
    s_mov_b32 s28, 917504
    s_add_u32 s30, s24, 0
    s_add_u32 m0, s30, 0
    s_nop 0
    buffer_load_dwordx4 v10, s[8:11], s29 offen lds
    s_add_u32 m0, s30, 4096
    s_nop 0
    buffer_load_dwordx4 v11, s[8:11], s29 offen lds
    s_add_u32 m0, s30, 8192
    s_nop 0
    buffer_load_dwordx4 v12, s[8:11], s29 offen lds
    s_add_u32 m0, s30, 12288
    s_nop 0
    buffer_load_dwordx4 v13, s[8:11], s29 offen lds
    s_mov_b32 s12, s60
    s_mov_b32 s13, s61
    s_add_u32 m0, s80, 16384
    s_nop 0
    buffer_load_dwordx4 v14, s[12:15], s29 offen lds
    s_mov_b32 s12, s62
    s_mov_b32 s13, s63
    s_add_u32 m0, s81, 16384
    s_nop 0
    buffer_load_dwordx4 v15, s[12:15], s29 offen lds
    s_mov_b32 s12, s64
    s_mov_b32 s13, s65
    s_add_u32 m0, s82, 16384
    s_nop 0
    buffer_load_dwordx4 v16, s[12:15], s29 offen lds
    s_mov_b32 s12, s66
    s_mov_b32 s13, s67
    s_add_u32 m0, s83, 16384
    s_nop 0
    buffer_load_dwordx4 v17, s[12:15], s29 offen lds
    s_mov_b32 s12, s68
    s_mov_b32 s13, s69
    s_add_u32 m0, s84, 16384
    s_nop 0
    buffer_load_dwordx4 v18, s[12:15], s29 offen lds
    s_add_u32 m0, s85, 16384
    s_nop 0
    buffer_load_dwordx4 v19, s[44:47], s28 offen lds
    s_waitcnt vmcnt(10)
    s_barrier
    s_mov_b32 s29, 640
    s_mov_b32 s28, 1146880
    s_add_u32 s30, s24, 38912
    s_add_u32 m0, s30, 0
    s_nop 0
    buffer_load_dwordx4 v10, s[8:11], s29 offen lds
    s_add_u32 m0, s30, 4096
    s_nop 0
    buffer_load_dwordx4 v11, s[8:11], s29 offen lds
    s_add_u32 m0, s30, 8192
    s_nop 0
    buffer_load_dwordx4 v12, s[8:11], s29 offen lds
    s_add_u32 m0, s30, 12288
    s_nop 0
    buffer_load_dwordx4 v13, s[8:11], s29 offen lds
    s_mov_b32 s12, s60
    s_mov_b32 s13, s61
    s_add_u32 m0, s80, 55296
    s_nop 0
    buffer_load_dwordx4 v14, s[12:15], s29 offen lds
    s_mov_b32 s12, s62
    s_mov_b32 s13, s63
    s_add_u32 m0, s81, 55296
    s_nop 0
    buffer_load_dwordx4 v15, s[12:15], s29 offen lds
    s_mov_b32 s12, s64
    s_mov_b32 s13, s65
    s_add_u32 m0, s82, 55296
    s_nop 0
    buffer_load_dwordx4 v16, s[12:15], s29 offen lds
    s_mov_b32 s12, s66
    s_mov_b32 s13, s67
    s_add_u32 m0, s83, 55296
    s_nop 0
    buffer_load_dwordx4 v17, s[12:15], s29 offen lds
    s_mov_b32 s12, s68
    s_mov_b32 s13, s69
    s_add_u32 m0, s84, 55296
    s_nop 0
    buffer_load_dwordx4 v18, s[12:15], s29 offen lds
    s_add_u32 m0, s85, 55296
    s_nop 0
    buffer_load_dwordx4 v19, s[44:47], s28 offen lds
    s_waitcnt vmcnt(10)
    s_barrier
    s_mov_b32 s29, 768
    s_mov_b32 s28, 1376256
    s_add_u32 s30, s24, 77824
    s_add_u32 m0, s30, 0
    s_nop 0
    buffer_load_dwordx4 v10, s[8:11], s29 offen lds
    s_add_u32 m0, s30, 4096
    s_nop 0
    buffer_load_dwordx4 v11, s[8:11], s29 offen lds
    s_add_u32 m0, s30, 8192
    s_nop 0
    buffer_load_dwordx4 v12, s[8:11], s29 offen lds
    s_add_u32 m0, s30, 12288
    s_nop 0
    buffer_load_dwordx4 v13, s[8:11], s29 offen lds
    s_mov_b32 s12, s60
    s_mov_b32 s13, s61
    s_add_u32 m0, s80, 94208
    s_nop 0
    buffer_load_dwordx4 v14, s[12:15], s29 offen lds
    s_mov_b32 s12, s62
    s_mov_b32 s13, s63
    s_add_u32 m0, s81, 94208
    s_nop 0
    buffer_load_dwordx4 v15, s[12:15], s29 offen lds
    s_mov_b32 s12, s64
    s_mov_b32 s13, s65
    s_add_u32 m0, s82, 94208
    s_nop 0
    buffer_load_dwordx4 v16, s[12:15], s29 offen lds
    s_mov_b32 s12, s66
    s_mov_b32 s13, s67
    s_add_u32 m0, s83, 94208
    s_nop 0
    buffer_load_dwordx4 v17, s[12:15], s29 offen lds
    s_mov_b32 s12, s68
    s_mov_b32 s13, s69
    s_add_u32 m0, s84, 94208
    s_nop 0
    buffer_load_dwordx4 v18, s[12:15], s29 offen lds
    s_add_u32 m0, s85, 94208
    s_nop 0
    buffer_load_dwordx4 v19, s[44:47], s28 offen lds
    s_waitcnt vmcnt(10)
    s_barrier
    s_mov_b32 s29, 896
    s_mov_b32 s28, 1605632
    s_add_u32 s30, s24, 116736
    s_add_u32 m0, s30, 0
    s_nop 0
    buffer_load_dwordx4 v10, s[8:11], s29 offen lds
    s_add_u32 m0, s30, 4096
    s_nop 0
    buffer_load_dwordx4 v11, s[8:11], s29 offen lds
    s_add_u32 m0, s30, 8192
    s_nop 0
    buffer_load_dwordx4 v12, s[8:11], s29 offen lds
    s_add_u32 m0, s30, 12288
    s_nop 0
    buffer_load_dwordx4 v13, s[8:11], s29 offen lds
    s_mov_b32 s12, s60
    s_mov_b32 s13, s61
    s_add_u32 m0, s80, 133120
    s_nop 0
    buffer_load_dwordx4 v14, s[12:15], s29 offen lds
    s_mov_b32 s12, s62
    s_mov_b32 s13, s63
    s_add_u32 m0, s81, 133120
    s_nop 0
    buffer_load_dwordx4 v15, s[12:15], s29 offen lds
    s_mov_b32 s12, s64
    s_mov_b32 s13, s65
    s_add_u32 m0, s82, 133120
    s_nop 0
    buffer_load_dwordx4 v16, s[12:15], s29 offen lds
    s_mov_b32 s12, s66
    s_mov_b32 s13, s67
    s_add_u32 m0, s83, 133120
    s_nop 0
    buffer_load_dwordx4 v17, s[12:15], s29 offen lds
    s_mov_b32 s12, s68
    s_mov_b32 s13, s69
    s_add_u32 m0, s84, 133120
    s_nop 0
    buffer_load_dwordx4 v18, s[12:15], s29 offen lds
    s_add_u32 m0, s85, 133120
    s_nop 0
    buffer_load_dwordx4 v19, s[44:47], s28 offen lds
    s_load_dwordx2 s[34:35], s[0:1], 8
    s_load_dwordx2 s[56:57], s[0:1], 16
    s_lshl_b32 s31, s2, 2
    s_add_u32 s31, s31, s18
    s_and_b32 s38, s31, 511
    s_lshl_b32 s38, s38, 14
    v_lshlrev_b32 v29, 7, v2
    v_add_u32 v29, s38, v29
    s_waitcnt lgkmcnt(0)
    s_cmp_ge_u32 s31, 512
    s_cselect_b32 s34, s56, s34
    s_cselect_b32 s35, s57, s35
    s_mov_b32 s56, s34
    s_mov_b32 s57, s35
    s_and_b32 s57, s57, 0xffff
    s_mov_b32 s58, 0x800000
    s_mov_b32 s59, 0x20000
    s_mov_b32 s31, 0
    buffer_load_dword v64, v29, s[56:59], s31 offen
    s_mov_b32 s31, 8192
    buffer_load_dword v65, v29, s[56:59], s31 offen
    s_waitcnt vmcnt(12)
    s_barrier
    v_mul_u32_u24 v28, 8*144, v26
    v_lshl_add_u32 v28, v25, 1, v28
    s_waitcnt vmcnt(53)
    ds_write_b16 v28, v160 offset:0
    ds_write_b16_d16_hi v28, v160 offset:144
    ds_write_b16 v28, v161 offset:288
    ds_write_b16_d16_hi v28, v161 offset:432
    ds_write_b16 v28, v162 offset:576
    ds_write_b16_d16_hi v28, v162 offset:720
    ds_write_b16 v28, v163 offset:864
    ds_write_b16_d16_hi v28, v163 offset:1008
    ds_write_b16 v28, v164 offset:64
    ds_write_b16_d16_hi v28, v164 offset:208
    ds_write_b16 v28, v165 offset:352
    ds_write_b16_d16_hi v28, v165 offset:496
    ds_write_b16 v28, v166 offset:640
    ds_write_b16_d16_hi v28, v166 offset:784
    ds_write_b16 v28, v167 offset:928
    ds_write_b16_d16_hi v28, v167 offset:1072
    s_waitcnt lgkmcnt(0)
    s_waitcnt vmcnt(2)
    s_barrier
    s_cmp_ge_u32 s2, 224
    s_cbranch_scc1 g1_tr2_skip_9
    v_mul_u32_u24 v28, 144, v25
    v_lshl_add_u32 v28, v26, 4, v28
    ds_read_b128 v[160:163], v28
    ds_read_b128 v[164:167], v28 offset:4608
    s_lshl_b32 s38, s37, 6
    s_lshl_b32 s39, s36, 7
    v_add_u32 v27, s38, v25
    v_lshlrev_b32 v27, 12, v27
    v_lshl_add_u32 v27, v26, 4, v27
    v_add_u32 v27, s39, v27
    s_mov_b32 s31, 0x20000
    s_waitcnt lgkmcnt(0)
    buffer_store_dwordx4 v[160:163], v27, s[52:55], 0 offen
    buffer_store_dwordx4 v[164:167], v27, s[52:55], s31 offen
g1_tr2_skip_9:
    s_barrier
    s_endpgm
g1_ld_0:
    s_add_u32 s26, s18, 0
    s_mov_b32 s90, s26
    s_lshl_b32 s27, s26, 10
    s_add_u32 s80, s27, 0
    s_lshl_b32 s27, s26, 6
    v_add_u32 v7, s27, v2
    v_mul_u32_u24 v8, 2979, v7
    v_lshrrev_b32 v8, 16, v8
    v_mul_u32_u24 v9, 22, v8
    v_sub_u32 v9, v7, v9
    v_mul_u32_u24 v8, 3584, v8
    v_lshl_add_u32 v14, v9, 4, v8
    s_add_u32 s27, s25, 0
    s_sub_u32 s27, s27, 1024
    s_lshl_b32 s27, s27, 1
    v_add_u32 v14, s27, v14
    s_add_u32 s26, s18, 4
    s_mov_b32 s90, s26
    s_lshl_b32 s27, s26, 10
    s_add_u32 s81, s27, 0
    s_lshl_b32 s27, s26, 6
    v_add_u32 v7, s27, v2
    v_mul_u32_u24 v8, 2979, v7
    v_lshrrev_b32 v8, 16, v8
    v_mul_u32_u24 v9, 22, v8
    v_sub_u32 v9, v7, v9
    v_mul_u32_u24 v8, 3584, v8
    v_lshl_add_u32 v15, v9, 4, v8
    s_add_u32 s27, s25, 0
    s_sub_u32 s27, s27, 1024
    s_lshl_b32 s27, s27, 1
    v_add_u32 v15, s27, v15
    s_add_u32 s26, s18, 8
    s_mov_b32 s90, s26
    s_lshl_b32 s27, s26, 10
    s_add_u32 s82, s27, 0
    s_lshl_b32 s27, s26, 6
    v_add_u32 v7, s27, v2
    v_mul_u32_u24 v8, 2979, v7
    v_lshrrev_b32 v8, 16, v8
    v_mul_u32_u24 v9, 22, v8
    v_sub_u32 v9, v7, v9
    v_mul_u32_u24 v8, 3584, v8
    v_lshl_add_u32 v16, v9, 4, v8
    s_add_u32 s27, s25, 0
    s_sub_u32 s27, s27, 1024
    s_lshl_b32 s27, s27, 1
    v_add_u32 v16, s27, v16
    s_add_u32 s26, s18, 12
    s_mov_b32 s90, s26
    s_lshl_b32 s27, s26, 10
    s_add_u32 s83, s27, 0
    s_lshl_b32 s27, s26, 6
    v_add_u32 v7, s27, v2
    v_mul_u32_u24 v8, 2979, v7
    v_lshrrev_b32 v8, 16, v8
    v_mul_u32_u24 v9, 22, v8
    v_sub_u32 v9, v7, v9
    v_mul_u32_u24 v8, 3584, v8
    v_lshl_add_u32 v17, v9, 4, v8
    s_add_u32 s27, s25, 0
    s_sub_u32 s27, s27, 1024
    s_lshl_b32 s27, s27, 1
    v_add_u32 v17, s27, v17
    s_add_u32 s26, s18, 16
    s_mov_b32 s90, s26
    s_lshl_b32 s27, s26, 10
    s_add_u32 s84, s27, 0
    s_lshl_b32 s27, s26, 6
    v_add_u32 v7, s27, v2
    v_mul_u32_u24 v8, 2979, v7
    v_lshrrev_b32 v8, 16, v8
    v_mul_u32_u24 v9, 22, v8
    v_sub_u32 v9, v7, v9
    v_mul_u32_u24 v8, 3584, v8
    v_lshl_add_u32 v18, v9, 4, v8
    s_add_u32 s27, s25, 0
    s_sub_u32 s27, s27, 1024
    s_lshl_b32 s27, s27, 1
    v_add_u32 v18, s27, v18
    s_add_u32 s26, s18, 20
    s_cmp_lt_u32 s26, 22
    s_cselect_b32 s26, s26, s90
    s_mov_b32 s90, s26
    s_lshl_b32 s27, s26, 10
    s_add_u32 s85, s27, 0
    s_lshl_b32 s27, s26, 6
    v_add_u32 v7, s27, v2
    v_mul_u32_u24 v8, 2979, v7
    v_lshrrev_b32 v8, 16, v8
    v_mul_u32_u24 v9, 22, v8
    v_sub_u32 v9, v7, v9
    v_mul_u32_u24 v8, 3584, v8
    v_lshl_add_u32 v19, v9, 4, v8
    s_add_u32 s27, s25, 0
    s_sub_u32 s27, s27, 1024
    s_lshl_b32 s27, s27, 1
    v_add_u32 v19, s27, v19
    s_mov_b32 s29, 0
    s_mov_b32 s28, 0
    s_add_u32 s30, s24, 0
    s_add_u32 m0, s30, 0
    s_nop 0
    buffer_load_dwordx4 v10, s[8:11], s29 offen lds
    s_add_u32 m0, s30, 4096
    s_nop 0
    buffer_load_dwordx4 v11, s[8:11], s29 offen lds
    s_add_u32 m0, s30, 8192
    s_nop 0
    buffer_load_dwordx4 v12, s[8:11], s29 offen lds
    s_add_u32 m0, s30, 12288
    s_nop 0
    buffer_load_dwordx4 v13, s[8:11], s29 offen lds
    s_add_u32 m0, s80, 16384
    s_nop 0
    buffer_load_dwordx4 v14, s[44:47], s28 offen lds
    s_add_u32 m0, s81, 16384
    s_nop 0
    buffer_load_dwordx4 v15, s[44:47], s28 offen lds
    s_add_u32 m0, s82, 16384
    s_nop 0
    buffer_load_dwordx4 v16, s[44:47], s28 offen lds
    s_add_u32 m0, s83, 16384
    s_nop 0
    buffer_load_dwordx4 v17, s[44:47], s28 offen lds
    s_add_u32 m0, s84, 16384
    s_nop 0
    buffer_load_dwordx4 v18, s[44:47], s28 offen lds
    s_add_u32 m0, s85, 16384
    s_nop 0
    buffer_load_dwordx4 v19, s[44:47], s28 offen lds
    s_mov_b32 s29, 128
    s_mov_b32 s28, 229376
    s_add_u32 s30, s24, 38912
    s_add_u32 m0, s30, 0
    s_nop 0
    buffer_load_dwordx4 v10, s[8:11], s29 offen lds
    s_add_u32 m0, s30, 4096
    s_nop 0
    buffer_load_dwordx4 v11, s[8:11], s29 offen lds
    s_add_u32 m0, s30, 8192
    s_nop 0
    buffer_load_dwordx4 v12, s[8:11], s29 offen lds
    s_add_u32 m0, s30, 12288
    s_nop 0
    buffer_load_dwordx4 v13, s[8:11], s29 offen lds
    s_add_u32 m0, s80, 55296
    s_nop 0
    buffer_load_dwordx4 v14, s[44:47], s28 offen lds
    s_add_u32 m0, s81, 55296
    s_nop 0
    buffer_load_dwordx4 v15, s[44:47], s28 offen lds
    s_add_u32 m0, s82, 55296
    s_nop 0
    buffer_load_dwordx4 v16, s[44:47], s28 offen lds
    s_add_u32 m0, s83, 55296
    s_nop 0
    buffer_load_dwordx4 v17, s[44:47], s28 offen lds
    s_add_u32 m0, s84, 55296
    s_nop 0
    buffer_load_dwordx4 v18, s[44:47], s28 offen lds
    s_add_u32 m0, s85, 55296
    s_nop 0
    buffer_load_dwordx4 v19, s[44:47], s28 offen lds
    s_mov_b32 s29, 256
    s_mov_b32 s28, 458752
    s_add_u32 s30, s24, 77824
    s_add_u32 m0, s30, 0
    s_nop 0
    buffer_load_dwordx4 v10, s[8:11], s29 offen lds
    s_add_u32 m0, s30, 4096
    s_nop 0
    buffer_load_dwordx4 v11, s[8:11], s29 offen lds
    s_add_u32 m0, s30, 8192
    s_nop 0
    buffer_load_dwordx4 v12, s[8:11], s29 offen lds
    s_add_u32 m0, s30, 12288
    s_nop 0
    buffer_load_dwordx4 v13, s[8:11], s29 offen lds
    s_add_u32 m0, s80, 94208
    s_nop 0
    buffer_load_dwordx4 v14, s[44:47], s28 offen lds
    s_add_u32 m0, s81, 94208
    s_nop 0
    buffer_load_dwordx4 v15, s[44:47], s28 offen lds
    s_add_u32 m0, s82, 94208
    s_nop 0
    buffer_load_dwordx4 v16, s[44:47], s28 offen lds
    s_add_u32 m0, s83, 94208
    s_nop 0
    buffer_load_dwordx4 v17, s[44:47], s28 offen lds
    s_add_u32 m0, s84, 94208
    s_nop 0
    buffer_load_dwordx4 v18, s[44:47], s28 offen lds
    s_add_u32 m0, s85, 94208
    s_nop 0
    buffer_load_dwordx4 v19, s[44:47], s28 offen lds
    v_mov_b32 v170, 0
    v_mov_b32 v171, 0
    v_mov_b32 v172, 0
    v_mov_b32 v173, 0
    v_mov_b32 v174, 0
    v_mov_b32 v175, 0
    v_mov_b32 v176, 0
    v_mov_b32 v177, 0
    s_lshl_b32 s31, s18, 12
    v_lshlrev_b32 v6, 4, v2
    v_add_u32 v6, s31, v6
    s_load_dwordx2 s[34:35], s[0:1], 64
    s_lshl_b32 s31, s18, 6
    v_add_u32 v24, s31, v2
    v_lshrrev_b32 v25, 3, v24
    v_and_b32 v26, 7, v24
    s_min_u32 s38, s2, 223
    s_lshr_b32 s36, s38, 3
    s_and_b32 s37, s38, 7
    s_waitcnt lgkmcnt(0)
    s_mov_b32 s48, s34
    s_mov_b32 s49, s35
    s_and_b32 s49, s49, 0xffff
    s_mov_b32 s50, 0x1c0000
    s_mov_b32 s51, 0x20000
    s_add_u32 s52, s6, 0x500000
    s_addc_u32 s53, s7, 0
    s_and_b32 s53, s53, 0xffff
    s_mov_b32 s54, 0x200000
    s_mov_b32 s55, 0x20000
    s_lshl_b32 s38, s36, 6
    s_lshl_b32 s39, s37, 7
    v_add_u32 v27, s38, v25
    v_lshlrev_b32 v27, 10, v27
    v_lshl_add_u32 v27, v26, 4, v27
    v_add_u32 v27, s39, v27
    s_mov_b32 s31, 0x8000
    buffer_load_dwordx4 v[160:163], v27, s[48:51], 0 offen
    buffer_load_dwordx4 v[164:167], v27, s[48:51], s31 offen
    s_waitcnt vmcnt(22)
    s_barrier
    s_waitcnt vmcnt(12)
    s_barrier
    s_add_u32 s56, s6, 0x1f00000
    s_addc_u32 s57, s7, 0
    s_and_b32 s57, s57, 0xffff
    s_mov_b32 s58, 0x8000
    s_mov_b32 s59, 0x20000
    s_lshl_b32 s31, s2, 7
    v_mov_b32 v28, s31
    v_mov_b32 v32, 0
    v_mov_b32 v33, 0
    v_mov_b32 v34, 0
    v_mov_b32 v35, 0
    buffer_store_dwordx4 v[32:35], v28, s[56:59], 0 offen
    s_mov_b32 s29, 384
    s_mov_b32 s28, 688128
    s_add_u32 s30, s24, 116736
    s_add_u32 m0, s30, 0
    s_nop 0
    buffer_load_dwordx4 v10, s[8:11], s29 offen lds
    s_add_u32 m0, s30, 4096
    s_nop 0
    buffer_load_dwordx4 v11, s[8:11], s29 offen lds
    s_add_u32 m0, s30, 8192
    s_nop 0
    buffer_load_dwordx4 v12, s[8:11], s29 offen lds
    s_add_u32 m0, s30, 12288
    s_nop 0
    buffer_load_dwordx4 v13, s[8:11], s29 offen lds
    s_add_u32 m0, s80, 133120
    s_nop 0
    buffer_load_dwordx4 v14, s[44:47], s28 offen lds
    s_add_u32 m0, s81, 133120
    s_nop 0
    buffer_load_dwordx4 v15, s[44:47], s28 offen lds
    s_add_u32 m0, s82, 133120
    s_nop 0
    buffer_load_dwordx4 v16, s[44:47], s28 offen lds
    s_add_u32 m0, s83, 133120
    s_nop 0
    buffer_load_dwordx4 v17, s[44:47], s28 offen lds
    s_add_u32 m0, s84, 133120
    s_nop 0
    buffer_load_dwordx4 v18, s[44:47], s28 offen lds
    s_add_u32 m0, s85, 133120
    s_nop 0
    buffer_load_dwordx4 v19, s[44:47], s28 offen lds
    s_waitcnt vmcnt(13)
    s_barrier
    s_mov_b32 s29, 512
    s_mov_b32 s28, 917504
    s_add_u32 s30, s24, 0
    s_add_u32 m0, s30, 0
    s_nop 0
    buffer_load_dwordx4 v10, s[8:11], s29 offen lds
    s_add_u32 m0, s30, 4096
    s_nop 0
    buffer_load_dwordx4 v11, s[8:11], s29 offen lds
    s_add_u32 m0, s30, 8192
    s_nop 0
    buffer_load_dwordx4 v12, s[8:11], s29 offen lds
    s_add_u32 m0, s30, 12288
    s_nop 0
    buffer_load_dwordx4 v13, s[8:11], s29 offen lds
    s_add_u32 m0, s80, 16384
    s_nop 0
    buffer_load_dwordx4 v14, s[44:47], s28 offen lds
    s_add_u32 m0, s81, 16384
    s_nop 0
    buffer_load_dwordx4 v15, s[44:47], s28 offen lds
    s_add_u32 m0, s82, 16384
    s_nop 0
    buffer_load_dwordx4 v16, s[44:47], s28 offen lds
    s_add_u32 m0, s83, 16384
    s_nop 0
    buffer_load_dwordx4 v17, s[44:47], s28 offen lds
    s_add_u32 m0, s84, 16384
    s_nop 0
    buffer_load_dwordx4 v18, s[44:47], s28 offen lds
    s_add_u32 m0, s85, 16384
    s_nop 0
    buffer_load_dwordx4 v19, s[44:47], s28 offen lds
    s_waitcnt vmcnt(10)
    s_barrier
    s_mov_b32 s29, 640
    s_mov_b32 s28, 1146880
    s_add_u32 s30, s24, 38912
    s_add_u32 m0, s30, 0
    s_nop 0
    buffer_load_dwordx4 v10, s[8:11], s29 offen lds
    s_add_u32 m0, s30, 4096
    s_nop 0
    buffer_load_dwordx4 v11, s[8:11], s29 offen lds
    s_add_u32 m0, s30, 8192
    s_nop 0
    buffer_load_dwordx4 v12, s[8:11], s29 offen lds
    s_add_u32 m0, s30, 12288
    s_nop 0
    buffer_load_dwordx4 v13, s[8:11], s29 offen lds
    s_add_u32 m0, s80, 55296
    s_nop 0
    buffer_load_dwordx4 v14, s[44:47], s28 offen lds
    s_add_u32 m0, s81, 55296
    s_nop 0
    buffer_load_dwordx4 v15, s[44:47], s28 offen lds
    s_add_u32 m0, s82, 55296
    s_nop 0
    buffer_load_dwordx4 v16, s[44:47], s28 offen lds
    s_add_u32 m0, s83, 55296
    s_nop 0
    buffer_load_dwordx4 v17, s[44:47], s28 offen lds
    s_add_u32 m0, s84, 55296
    s_nop 0
    buffer_load_dwordx4 v18, s[44:47], s28 offen lds
    s_add_u32 m0, s85, 55296
    s_nop 0
    buffer_load_dwordx4 v19, s[44:47], s28 offen lds
    s_waitcnt vmcnt(10)
    s_barrier
    s_mov_b32 s29, 768
    s_mov_b32 s28, 1376256
    s_add_u32 s30, s24, 77824
    s_add_u32 m0, s30, 0
    s_nop 0
    buffer_load_dwordx4 v10, s[8:11], s29 offen lds
    s_add_u32 m0, s30, 4096
    s_nop 0
    buffer_load_dwordx4 v11, s[8:11], s29 offen lds
    s_add_u32 m0, s30, 8192
    s_nop 0
    buffer_load_dwordx4 v12, s[8:11], s29 offen lds
    s_add_u32 m0, s30, 12288
    s_nop 0
    buffer_load_dwordx4 v13, s[8:11], s29 offen lds
    s_add_u32 m0, s80, 94208
    s_nop 0
    buffer_load_dwordx4 v14, s[44:47], s28 offen lds
    s_add_u32 m0, s81, 94208
    s_nop 0
    buffer_load_dwordx4 v15, s[44:47], s28 offen lds
    s_add_u32 m0, s82, 94208
    s_nop 0
    buffer_load_dwordx4 v16, s[44:47], s28 offen lds
    s_add_u32 m0, s83, 94208
    s_nop 0
    buffer_load_dwordx4 v17, s[44:47], s28 offen lds
    s_add_u32 m0, s84, 94208
    s_nop 0
    buffer_load_dwordx4 v18, s[44:47], s28 offen lds
    s_add_u32 m0, s85, 94208
    s_nop 0
    buffer_load_dwordx4 v19, s[44:47], s28 offen lds
    s_waitcnt vmcnt(10)
    s_barrier
    s_mov_b32 s29, 896
    s_mov_b32 s28, 1605632
    s_add_u32 s30, s24, 116736
    s_add_u32 m0, s30, 0
    s_nop 0
    buffer_load_dwordx4 v10, s[8:11], s29 offen lds
    s_add_u32 m0, s30, 4096
    s_nop 0
    buffer_load_dwordx4 v11, s[8:11], s29 offen lds
    s_add_u32 m0, s30, 8192
    s_nop 0
    buffer_load_dwordx4 v12, s[8:11], s29 offen lds
    s_add_u32 m0, s30, 12288
    s_nop 0
    buffer_load_dwordx4 v13, s[8:11], s29 offen lds
    s_add_u32 m0, s80, 133120
    s_nop 0
    buffer_load_dwordx4 v14, s[44:47], s28 offen lds
    s_add_u32 m0, s81, 133120
    s_nop 0
    buffer_load_dwordx4 v15, s[44:47], s28 offen lds
    s_add_u32 m0, s82, 133120
    s_nop 0
    buffer_load_dwordx4 v16, s[44:47], s28 offen lds
    s_add_u32 m0, s83, 133120
    s_nop 0
    buffer_load_dwordx4 v17, s[44:47], s28 offen lds
    s_add_u32 m0, s84, 133120
    s_nop 0
    buffer_load_dwordx4 v18, s[44:47], s28 offen lds
    s_add_u32 m0, s85, 133120
    s_nop 0
    buffer_load_dwordx4 v19, s[44:47], s28 offen lds
    s_load_dwordx2 s[34:35], s[0:1], 8
    s_load_dwordx2 s[56:57], s[0:1], 16
    s_lshl_b32 s31, s2, 2
    s_add_u32 s31, s31, s18
    s_and_b32 s38, s31, 511
    s_lshl_b32 s38, s38, 14
    v_lshlrev_b32 v29, 7, v2
    v_add_u32 v29, s38, v29
    s_waitcnt lgkmcnt(0)
    s_cmp_ge_u32 s31, 512
    s_cselect_b32 s34, s56, s34
    s_cselect_b32 s35, s57, s35
    s_mov_b32 s56, s34
    s_mov_b32 s57, s35
    s_and_b32 s57, s57, 0xffff
    s_mov_b32 s58, 0x800000
    s_mov_b32 s59, 0x20000
    s_mov_b32 s31, 0
    buffer_load_dword v64, v29, s[56:59], s31 offen
    s_mov_b32 s31, 8192
    buffer_load_dword v65, v29, s[56:59], s31 offen
    s_waitcnt vmcnt(12)
    s_barrier
    v_mul_u32_u24 v28, 8*144, v26
    v_lshl_add_u32 v28, v25, 1, v28
    s_waitcnt vmcnt(53)
    ds_write_b16 v28, v160 offset:0
    ds_write_b16_d16_hi v28, v160 offset:144
    ds_write_b16 v28, v161 offset:288
    ds_write_b16_d16_hi v28, v161 offset:432
    ds_write_b16 v28, v162 offset:576
    ds_write_b16_d16_hi v28, v162 offset:720
    ds_write_b16 v28, v163 offset:864
    ds_write_b16_d16_hi v28, v163 offset:1008
    ds_write_b16 v28, v164 offset:64
    ds_write_b16_d16_hi v28, v164 offset:208
    ds_write_b16 v28, v165 offset:352
    ds_write_b16_d16_hi v28, v165 offset:496
    ds_write_b16 v28, v166 offset:640
    ds_write_b16_d16_hi v28, v166 offset:784
    ds_write_b16 v28, v167 offset:928
    ds_write_b16_d16_hi v28, v167 offset:1072
    s_waitcnt lgkmcnt(0)
    s_waitcnt vmcnt(2)
    s_barrier
    s_cmp_ge_u32 s2, 224
    s_cbranch_scc1 g1_tr2_skip_0
    v_mul_u32_u24 v28, 144, v25
    v_lshl_add_u32 v28, v26, 4, v28
    ds_read_b128 v[160:163], v28
    ds_read_b128 v[164:167], v28 offset:4608
    s_lshl_b32 s38, s37, 6
    s_lshl_b32 s39, s36, 7
    v_add_u32 v27, s38, v25
    v_lshlrev_b32 v27, 12, v27
    v_lshl_add_u32 v27, v26, 4, v27
    v_add_u32 v27, s39, v27
    s_mov_b32 s31, 0x20000
    s_waitcnt lgkmcnt(0)
    buffer_store_dwordx4 v[160:163], v27, s[52:55], 0 offen
    buffer_store_dwordx4 v[164:167], v27, s[52:55], s31 offen
g1_tr2_skip_0:
    s_barrier
    s_endpgm
g1_compute:
    v_and_b32 v5, 15, v2
    v_lshrrev_b32 v6, 4, v2
    v_lshrrev_b32 v7, 1, v5
    v_and_b32 v7, 7, v7
    v_xor_b32 v7, v6, v7
    v_lshlrev_b32 v7, 4, v7
    v_lshl_add_u32 v7, v5, 7, v7
    s_lshl_b32 s25, s18, 12
    v_add_u32 v20, s25, v7
    v_xor_b32 v21, 64, v20
    v_add_u32 v22, 0x4000, v7
    v_xor_b32 v23, 64, v22
    v_mov_b32 v24, 0
    v_mov_b32 v25, 0
    v_mov_b32 v26, 0
    v_mov_b32 v27, 0
    v_mov_b32 v28, 0
    v_mov_b32 v29, 0
    v_mov_b32 v30, 0
    v_mov_b32 v31, 0
    v_mov_b32 v32, 0
    v_mov_b32 v33, 0
    v_mov_b32 v34, 0
    v_mov_b32 v35, 0
    v_mov_b32 v36, 0
    v_mov_b32 v37, 0
    v_mov_b32 v38, 0
    v_mov_b32 v39, 0
    v_mov_b32 v40, 0
    v_mov_b32 v41, 0
    v_mov_b32 v42, 0
    v_mov_b32 v43, 0
    v_mov_b32 v44, 0
    v_mov_b32 v45, 0
    v_mov_b32 v46, 0
    v_mov_b32 v47, 0
    v_mov_b32 v48, 0
    v_mov_b32 v49, 0
    v_mov_b32 v50, 0
    v_mov_b32 v51, 0
    v_mov_b32 v52, 0
    v_mov_b32 v53, 0
    v_mov_b32 v54, 0
    v_mov_b32 v55, 0
    v_mov_b32 v56, 0
    v_mov_b32 v57, 0
    v_mov_b32 v58, 0
    v_mov_b32 v59, 0
    v_mov_b32 v60, 0
    v_mov_b32 v61, 0
    v_mov_b32 v62, 0
    v_mov_b32 v63, 0
    v_mov_b32 v64, 0
    v_mov_b32 v65, 0
    v_mov_b32 v66, 0
    v_mov_b32 v67, 0
    v_mov_b32 v68, 0
    v_mov_b32 v69, 0
    v_mov_b32 v70, 0
    v_mov_b32 v71, 0
    v_mov_b32 v72, 0
    v_mov_b32 v73, 0
    v_mov_b32 v74, 0
    v_mov_b32 v75, 0
    v_mov_b32 v76, 0
    v_mov_b32 v77, 0
    v_mov_b32 v78, 0
    v_mov_b32 v79, 0
    v_mov_b32 v80, 0
    v_mov_b32 v81, 0
    v_mov_b32 v82, 0
    v_mov_b32 v83, 0
    v_mov_b32 v84, 0
    v_mov_b32 v85, 0
    v_mov_b32 v86, 0
    v_mov_b32 v87, 0
    v_mov_b32 v88, 0
    v_mov_b32 v89, 0
    v_mov_b32 v90, 0
    v_mov_b32 v91, 0
    v_mov_b32 v92, 0
    v_mov_b32 v93, 0
    v_mov_b32 v94, 0
    v_mov_b32 v95, 0
    v_mov_b32 v96, 0
    v_mov_b32 v97, 0
    v_mov_b32 v98, 0
    v_mov_b32 v99, 0
    v_mov_b32 v100, 0
    v_mov_b32 v101, 0
    v_mov_b32 v102, 0
    v_mov_b32 v103, 0
    v_mov_b32 v104, 0
    v_mov_b32 v105, 0
    v_mov_b32 v106, 0
    v_mov_b32 v107, 0
    v_mov_b32 v108, 0
    v_mov_b32 v109, 0
    v_mov_b32 v110, 0
    v_mov_b32 v111, 0
    v_mov_b32 v212, 0
    v_mov_b32 v213, 0
    v_mov_b32 v214, 0
    v_mov_b32 v216, 0
    v_mov_b32 v217, 0
    v_mov_b32 v218, 0
    v_mov_b32 v219, 0
    v_mov_b32 v9, 0
    v_lshlrev_b32 v8, 2, v2
    v_add_u32 v8, 156672, v8
    s_cmp_lg_u32 s18, 0
    s_cbranch_scc1 g1_nz
    ds_write_b32 v8, v9 offset:0
    ds_write_b32 v8, v9 offset:256
    ds_write_b32 v8, v9 offset:512
    ds_write_b32 v8, v9 offset:768
    ds_write_b32 v8, v9 offset:1024
    s_waitcnt lgkmcnt(0)
g1_nz:
    s_mov_b32 s28, 0
    s_mov_b32 s33, 0x3f803f80
    s_mov_b32 s32, 0
    s_cmp_lt_u32 s17, 5
    s_cbranch_scc1 g1_c_11
    s_cmp_eq_u32 s17, 5
    s_cbranch_scc1 g1_c_9
    s_branch g1_c_0
g1_c_11:
    s_barrier
    ds_read_b128 v[112:115], v20
    ds_read_b128 v[116:119], v20 offset:2048
    ds_read_b128 v[128:131], v22 offset:0
    ds_read_b128 v[132:135], v22 offset:2048
    ds_read_b128 v[136:139], v22 offset:4096
    ds_read_b128 v[140:143], v22 offset:6144
    ds_read_b128 v[144:147], v22 offset:8192
    ds_read_b128 v[148:151], v22 offset:10240
    s_cmp_eq_u32 s18, 1
    s_cbranch_scc1 g1_loop_11_1
    s_cmp_eq_u32 s18, 2
    s_cbranch_scc1 g1_loop_11_2
    s_cmp_eq_u32 s18, 3
    s_cbranch_scc1 g1_loop_11_3
g1_loop_11_0:
    ds_read_b128 v[152:155], v22 offset:12288
    s_waitcnt lgkmcnt(6)
    v_mfma_f32_16x16x32_bf16 v[24:27], v[112:115], v[128:131], v[24:27]
    v_mfma_f32_16x16x32_bf16 v[28:31], v[116:119], v[128:131], v[28:31]
    v_dot2c_f32_bf16 v212, s33, v128
    v_dot2c_f32_bf16 v212, s33, v129
    v_dot2c_f32_bf16 v212, s33, v130
    v_dot2c_f32_bf16 v212, s33, v131
    v_dot2c_f32_bf16 v216, s33, v112
    v_dot2c_f32_bf16 v217, v112, v112
    ds_read_b128 v[156:159], v22 offset:14336
    s_waitcnt lgkmcnt(6)
    v_mfma_f32_16x16x32_bf16 v[32:35], v[112:115], v[132:135], v[32:35]
    v_mfma_f32_16x16x32_bf16 v[36:39], v[116:119], v[132:135], v[36:39]
    v_dot2c_f32_bf16 v216, s33, v113
    v_dot2c_f32_bf16 v217, v113, v113
    ds_read_b128 v[160:163], v22 offset:16384
    s_waitcnt lgkmcnt(6)
    v_mfma_f32_16x16x32_bf16 v[40:43], v[112:115], v[136:139], v[40:43]
    v_mfma_f32_16x16x32_bf16 v[44:47], v[116:119], v[136:139], v[44:47]
    v_dot2c_f32_bf16 v216, s33, v114
    v_dot2c_f32_bf16 v217, v114, v114
    ds_read_b128 v[164:167], v22 offset:18432
    s_waitcnt lgkmcnt(6)
    v_mfma_f32_16x16x32_bf16 v[48:51], v[112:115], v[140:143], v[48:51]
    v_mfma_f32_16x16x32_bf16 v[52:55], v[116:119], v[140:143], v[52:55]
    v_dot2c_f32_bf16 v216, s33, v115
    v_dot2c_f32_bf16 v217, v115, v115
    ds_read_b128 v[168:171], v22 offset:20480
    s_waitcnt lgkmcnt(6)
    v_mfma_f32_16x16x32_bf16 v[56:59], v[112:115], v[144:147], v[56:59]
    v_mfma_f32_16x16x32_bf16 v[60:63], v[116:119], v[144:147], v[60:63]
    v_dot2c_f32_bf16 v213, s33, v144
    v_dot2c_f32_bf16 v213, s33, v145
    v_dot2c_f32_bf16 v213, s33, v146
    v_dot2c_f32_bf16 v213, s33, v147
    v_dot2c_f32_bf16 v218, s33, v116
    v_dot2c_f32_bf16 v219, v116, v116
    ds_read_b128 v[120:123], v21
    ds_read_b128 v[124:127], v21 offset:2048
    ds_read_b128 v[128:131], v23 offset:0
    s_waitcnt lgkmcnt(8)
    v_mfma_f32_16x16x32_bf16 v[64:67], v[112:115], v[148:151], v[64:67]
    v_mfma_f32_16x16x32_bf16 v[68:71], v[116:119], v[148:151], v[68:71]
    v_dot2c_f32_bf16 v218, s33, v117
    v_dot2c_f32_bf16 v219, v117, v117
    ds_read_b128 v[132:135], v23 offset:2048
    s_waitcnt lgkmcnt(8)
    v_mfma_f32_16x16x32_bf16 v[72:75], v[112:115], v[152:155], v[72:75]
    v_mfma_f32_16x16x32_bf16 v[76:79], v[116:119], v[152:155], v[76:79]
    v_dot2c_f32_bf16 v218, s33, v118
    v_dot2c_f32_bf16 v219, v118, v118
    ds_read_b128 v[136:139], v23 offset:4096
    s_waitcnt lgkmcnt(8)
    v_mfma_f32_16x16x32_bf16 v[80:83], v[112:115], v[156:159], v[80:83]
    v_mfma_f32_16x16x32_bf16 v[84:87], v[116:119], v[156:159], v[84:87]
    v_dot2c_f32_bf16 v218, s33, v119
    v_dot2c_f32_bf16 v219, v119, v119
    ds_read_b128 v[140:143], v23 offset:6144
    s_waitcnt lgkmcnt(8)
    v_mfma_f32_16x16x32_bf16 v[88:91], v[112:115], v[160:163], v[88:91]
    v_mfma_f32_16x16x32_bf16 v[92:95], v[116:119], v[160:163], v[92:95]
    v_dot2c_f32_bf16 v214, s33, v160
    v_dot2c_f32_bf16 v214, s33, v161
    v_dot2c_f32_bf16 v214, s33, v162
    v_dot2c_f32_bf16 v214, s33, v163
    ds_read_b128 v[144:147], v23 offset:8192
    s_waitcnt lgkmcnt(8)
    v_mfma_f32_16x16x32_bf16 v[96:99], v[112:115], v[164:167], v[96:99]
    v_mfma_f32_16x16x32_bf16 v[100:103], v[116:119], v[164:167], v[100:103]
    ds_read_b128 v[148:151], v23 offset:10240
    s_waitcnt lgkmcnt(8)
    v_mfma_f32_16x16x32_bf16 v[104:107], v[112:115], v[168:171], v[104:107]
    v_mfma_f32_16x16x32_bf16 v[108:111], v[116:119], v[168:171], v[108:111]
    ds_read_b128 v[152:155], v23 offset:12288
    s_waitcnt lgkmcnt(6)
    v_mfma_f32_16x16x32_bf16 v[24:27], v[120:123], v[128:131], v[24:27]
    v_mfma_f32_16x16x32_bf16 v[28:31], v[124:127], v[128:131], v[28:31]
    v_dot2c_f32_bf16 v212, s33, v128
    v_dot2c_f32_bf16 v212, s33, v129
    v_dot2c_f32_bf16 v212, s33, v130
    v_dot2c_f32_bf16 v212, s33, v131
    v_dot2c_f32_bf16 v216, s33, v120
    v_dot2c_f32_bf16 v217, v120, v120
    ds_read_b128 v[156:159], v23 offset:14336
    s_waitcnt lgkmcnt(6)
    v_mfma_f32_16x16x32_bf16 v[32:35], v[120:123], v[132:135], v[32:35]
    v_mfma_f32_16x16x32_bf16 v[36:39], v[124:127], v[132:135], v[36:39]
    v_dot2c_f32_bf16 v216, s33, v121
    v_dot2c_f32_bf16 v217, v121, v121
    ds_read_b128 v[160:163], v23 offset:16384
    s_waitcnt lgkmcnt(6)
    v_mfma_f32_16x16x32_bf16 v[40:43], v[120:123], v[136:139], v[40:43]
    v_mfma_f32_16x16x32_bf16 v[44:47], v[124:127], v[136:139], v[44:47]
    v_dot2c_f32_bf16 v216, s33, v122
    v_dot2c_f32_bf16 v217, v122, v122
    ds_read_b128 v[164:167], v23 offset:18432
    s_waitcnt lgkmcnt(6)
    v_mfma_f32_16x16x32_bf16 v[48:51], v[120:123], v[140:143], v[48:51]
    v_mfma_f32_16x16x32_bf16 v[52:55], v[124:127], v[140:143], v[52:55]
    v_dot2c_f32_bf16 v216, s33, v123
    v_dot2c_f32_bf16 v217, v123, v123
    ds_read_b128 v[168:171], v23 offset:20480
    s_waitcnt lgkmcnt(6)
    v_mfma_f32_16x16x32_bf16 v[56:59], v[120:123], v[144:147], v[56:59]
    v_mfma_f32_16x16x32_bf16 v[60:63], v[124:127], v[144:147], v[60:63]
    v_dot2c_f32_bf16 v213, s33, v144
    v_dot2c_f32_bf16 v213, s33, v145
    v_dot2c_f32_bf16 v213, s33, v146
    v_dot2c_f32_bf16 v213, s33, v147
    v_dot2c_f32_bf16 v218, s33, v124
    v_dot2c_f32_bf16 v219, v124, v124
    s_barrier
    s_add_u32 s28, s28, 38912
    s_cmp_ge_u32 s28, 155648
    s_cselect_b32 s34, 155648, 0
    s_cselect_b32 s28, 0, s28
    s_sub_u32 s34, 38912, s34
    v_add_u32 v20, s34, v20
    v_add_u32 v21, s34, v21
    v_add_u32 v22, s34, v22
    v_add_u32 v23, s34, v23
    ds_read_b128 v[112:115], v20
    ds_read_b128 v[116:119], v20 offset:2048
    ds_read_b128 v[128:131], v22 offset:0
    s_waitcnt lgkmcnt(8)
    v_mfma_f32_16x16x32_bf16 v[64:67], v[120:123], v[148:151], v[64:67]
    v_mfma_f32_16x16x32_bf16 v[68:71], v[124:127], v[148:151], v[68:71]
    v_dot2c_f32_bf16 v218, s33, v125
    v_dot2c_f32_bf16 v219, v125, v125
    ds_read_b128 v[132:135], v22 offset:2048
    s_waitcnt lgkmcnt(8)
    v_mfma_f32_16x16x32_bf16 v[72:75], v[120:123], v[152:155], v[72:75]
    v_mfma_f32_16x16x32_bf16 v[76:79], v[124:127], v[152:155], v[76:79]
    v_dot2c_f32_bf16 v218, s33, v126
    v_dot2c_f32_bf16 v219, v126, v126
    ds_read_b128 v[136:139], v22 offset:4096
    s_waitcnt lgkmcnt(8)
    v_mfma_f32_16x16x32_bf16 v[80:83], v[120:123], v[156:159], v[80:83]
    v_mfma_f32_16x16x32_bf16 v[84:87], v[124:127], v[156:159], v[84:87]
    v_dot2c_f32_bf16 v218, s33, v127
    v_dot2c_f32_bf16 v219, v127, v127
    ds_read_b128 v[140:143], v22 offset:6144
    s_waitcnt lgkmcnt(8)
    v_mfma_f32_16x16x32_bf16 v[88:91], v[120:123], v[160:163], v[88:91]
    v_mfma_f32_16x16x32_bf16 v[92:95], v[124:127], v[160:163], v[92:95]
    v_dot2c_f32_bf16 v214, s33, v160
    v_dot2c_f32_bf16 v214, s33, v161
    v_dot2c_f32_bf16 v214, s33, v162
    v_dot2c_f32_bf16 v214, s33, v163
    ds_read_b128 v[144:147], v22 offset:8192
    s_waitcnt lgkmcnt(8)
    v_mfma_f32_16x16x32_bf16 v[96:99], v[120:123], v[164:167], v[96:99]
    v_mfma_f32_16x16x32_bf16 v[100:103], v[124:127], v[164:167], v[100:103]
    ds_read_b128 v[148:151], v22 offset:10240
    s_waitcnt lgkmcnt(8)
    v_mfma_f32_16x16x32_bf16 v[104:107], v[120:123], v[168:171], v[104:107]
    v_mfma_f32_16x16x32_bf16 v[108:111], v[124:127], v[168:171], v[108:111]
    s_add_u32 s32, s32, 1
    s_cmp_lt_u32 s32, 8
    s_cbranch_scc1 g1_loop_11_0
    s_branch g1_post_11
g1_loop_11_1:
    ds_read_b128 v[152:155], v22 offset:12288
    s_waitcnt lgkmcnt(6)
    v_mfma_f32_16x16x32_bf16 v[24:27], v[112:115], v[128:131], v[24:27]
    v_mfma_f32_16x16x32_bf16 v[28:31], v[116:119], v[128:131], v[28:31]
    v_dot2c_f32_bf16 v216, s33, v112
    v_dot2c_f32_bf16 v217, v112, v112
    ds_read_b128 v[156:159], v22 offset:14336
    s_waitcnt lgkmcnt(6)
    v_mfma_f32_16x16x32_bf16 v[32:35], v[112:115], v[132:135], v[32:35]
    v_mfma_f32_16x16x32_bf16 v[36:39], v[116:119], v[132:135], v[36:39]
    v_dot2c_f32_bf16 v212, s33, v132
    v_dot2c_f32_bf16 v212, s33, v133
    v_dot2c_f32_bf16 v212, s33, v134
    v_dot2c_f32_bf16 v212, s33, v135
    v_dot2c_f32_bf16 v216, s33, v113
    v_dot2c_f32_bf16 v217, v113, v113
    ds_read_b128 v[160:163], v22 offset:16384
    s_waitcnt lgkmcnt(6)
    v_mfma_f32_16x16x32_bf16 v[40:43], v[112:115], v[136:139], v[40:43]
    v_mfma_f32_16x16x32_bf16 v[44:47], v[116:119], v[136:139], v[44:47]
    v_dot2c_f32_bf16 v216, s33, v114
    v_dot2c_f32_bf16 v217, v114, v114
    ds_read_b128 v[164:167], v22 offset:18432
    s_waitcnt lgkmcnt(6)
    v_mfma_f32_16x16x32_bf16 v[48:51], v[112:115], v[140:143], v[48:51]
    v_mfma_f32_16x16x32_bf16 v[52:55], v[116:119], v[140:143], v[52:55]
    v_dot2c_f32_bf16 v216, s33, v115
    v_dot2c_f32_bf16 v217, v115, v115
    ds_read_b128 v[168:171], v22 offset:20480
    s_waitcnt lgkmcnt(6)
    v_mfma_f32_16x16x32_bf16 v[56:59], v[112:115], v[144:147], v[56:59]
    v_mfma_f32_16x16x32_bf16 v[60:63], v[116:119], v[144:147], v[60:63]
    v_dot2c_f32_bf16 v218, s33, v116
    v_dot2c_f32_bf16 v219, v116, v116
    ds_read_b128 v[120:123], v21
    ds_read_b128 v[124:127], v21 offset:2048
    ds_read_b128 v[128:131], v23 offset:0
    s_waitcnt lgkmcnt(8)
    v_mfma_f32_16x16x32_bf16 v[64:67], v[112:115], v[148:151], v[64:67]
    v_mfma_f32_16x16x32_bf16 v[68:71], v[116:119], v[148:151], v[68:71]
    v_dot2c_f32_bf16 v213, s33, v148
    v_dot2c_f32_bf16 v213, s33, v149
    v_dot2c_f32_bf16 v213, s33, v150
    v_dot2c_f32_bf16 v213, s33, v151
    v_dot2c_f32_bf16 v218, s33, v117
    v_dot2c_f32_bf16 v219, v117, v117
    ds_read_b128 v[132:135], v23 offset:2048
    s_waitcnt lgkmcnt(8)
    v_mfma_f32_16x16x32_bf16 v[72:75], v[112:115], v[152:155], v[72:75]
    v_mfma_f32_16x16x32_bf16 v[76:79], v[116:119], v[152:155], v[76:79]
    v_dot2c_f32_bf16 v218, s33, v118
    v_dot2c_f32_bf16 v219, v118, v118
    ds_read_b128 v[136:139], v23 offset:4096
    s_waitcnt lgkmcnt(8)
    v_mfma_f32_16x16x32_bf16 v[80:83], v[112:115], v[156:159], v[80:83]
    v_mfma_f32_16x16x32_bf16 v[84:87], v[116:119], v[156:159], v[84:87]
    v_dot2c_f32_bf16 v218, s33, v119
    v_dot2c_f32_bf16 v219, v119, v119
    ds_read_b128 v[140:143], v23 offset:6144
    s_waitcnt lgkmcnt(8)
    v_mfma_f32_16x16x32_bf16 v[88:91], v[112:115], v[160:163], v[88:91]
    v_mfma_f32_16x16x32_bf16 v[92:95], v[116:119], v[160:163], v[92:95]
    ds_read_b128 v[144:147], v23 offset:8192
    s_waitcnt lgkmcnt(8)
    v_mfma_f32_16x16x32_bf16 v[96:99], v[112:115], v[164:167], v[96:99]
    v_mfma_f32_16x16x32_bf16 v[100:103], v[116:119], v[164:167], v[100:103]
    v_dot2c_f32_bf16 v214, s33, v164
    v_dot2c_f32_bf16 v214, s33, v165
    v_dot2c_f32_bf16 v214, s33, v166
    v_dot2c_f32_bf16 v214, s33, v167
    ds_read_b128 v[148:151], v23 offset:10240
    s_waitcnt lgkmcnt(8)
    v_mfma_f32_16x16x32_bf16 v[104:107], v[112:115], v[168:171], v[104:107]
    v_mfma_f32_16x16x32_bf16 v[108:111], v[116:119], v[168:171], v[108:111]
    ds_read_b128 v[152:155], v23 offset:12288
    s_waitcnt lgkmcnt(6)
    v_mfma_f32_16x16x32_bf16 v[24:27], v[120:123], v[128:131], v[24:27]
    v_mfma_f32_16x16x32_bf16 v[28:31], v[124:127], v[128:131], v[28:31]
    v_dot2c_f32_bf16 v216, s33, v120
    v_dot2c_f32_bf16 v217, v120, v120
    ds_read_b128 v[156:159], v23 offset:14336
    s_waitcnt lgkmcnt(6)
    v_mfma_f32_16x16x32_bf16 v[32:35], v[120:123], v[132:135], v[32:35]
    v_mfma_f32_16x16x32_bf16 v[36:39], v[124:127], v[132:135], v[36:39]
    v_dot2c_f32_bf16 v212, s33, v132
    v_dot2c_f32_bf16 v212, s33, v133
    v_dot2c_f32_bf16 v212, s33, v134
    v_dot2c_f32_bf16 v212, s33, v135
    v_dot2c_f32_bf16 v216, s33, v121
    v_dot2c_f32_bf16 v217, v121, v121
    ds_read_b128 v[160:163], v23 offset:16384
    s_waitcnt lgkmcnt(6)
    v_mfma_f32_16x16x32_bf16 v[40:43], v[120:123], v[136:139], v[40:43]
    v_mfma_f32_16x16x32_bf16 v[44:47], v[124:127], v[136:139], v[44:47]
    v_dot2c_f32_bf16 v216, s33, v122
    v_dot2c_f32_bf16 v217, v122, v122
    ds_read_b128 v[164:167], v23 offset:18432
    s_waitcnt lgkmcnt(6)
    v_mfma_f32_16x16x32_bf16 v[48:51], v[120:123], v[140:143], v[48:51]
    v_mfma_f32_16x16x32_bf16 v[52:55], v[124:127], v[140:143], v[52:55]
    v_dot2c_f32_bf16 v216, s33, v123
    v_dot2c_f32_bf16 v217, v123, v123
    ds_read_b128 v[168:171], v23 offset:20480
    s_waitcnt lgkmcnt(6)
    v_mfma_f32_16x16x32_bf16 v[56:59], v[120:123], v[144:147], v[56:59]
    v_mfma_f32_16x16x32_bf16 v[60:63], v[124:127], v[144:147], v[60:63]
    v_dot2c_f32_bf16 v218, s33, v124
    v_dot2c_f32_bf16 v219, v124, v124
    s_barrier
    s_add_u32 s28, s28, 38912
    s_cmp_ge_u32 s28, 155648
    s_cselect_b32 s34, 155648, 0
    s_cselect_b32 s28, 0, s28
    s_sub_u32 s34, 38912, s34
    v_add_u32 v20, s34, v20
    v_add_u32 v21, s34, v21
    v_add_u32 v22, s34, v22
    v_add_u32 v23, s34, v23
    ds_read_b128 v[112:115], v20
    ds_read_b128 v[116:119], v20 offset:2048
    ds_read_b128 v[128:131], v22 offset:0
    s_waitcnt lgkmcnt(8)
    v_mfma_f32_16x16x32_bf16 v[64:67], v[120:123], v[148:151], v[64:67]
    v_mfma_f32_16x16x32_bf16 v[68:71], v[124:127], v[148:151], v[68:71]
    v_dot2c_f32_bf16 v213, s33, v148
    v_dot2c_f32_bf16 v213, s33, v149
    v_dot2c_f32_bf16 v213, s33, v150
    v_dot2c_f32_bf16 v213, s33, v151
    v_dot2c_f32_bf16 v218, s33, v125
    v_dot2c_f32_bf16 v219, v125, v125
    ds_read_b128 v[132:135], v22 offset:2048
    s_waitcnt lgkmcnt(8)
    v_mfma_f32_16x16x32_bf16 v[72:75], v[120:123], v[152:155], v[72:75]
    v_mfma_f32_16x16x32_bf16 v[76:79], v[124:127], v[152:155], v[76:79]
    v_dot2c_f32_bf16 v218, s33, v126
    v_dot2c_f32_bf16 v219, v126, v126
    ds_read_b128 v[136:139], v22 offset:4096
    s_waitcnt lgkmcnt(8)
    v_mfma_f32_16x16x32_bf16 v[80:83], v[120:123], v[156:159], v[80:83]
    v_mfma_f32_16x16x32_bf16 v[84:87], v[124:127], v[156:159], v[84:87]
    v_dot2c_f32_bf16 v218, s33, v127
    v_dot2c_f32_bf16 v219, v127, v127
    ds_read_b128 v[140:143], v22 offset:6144
    s_waitcnt lgkmcnt(8)
    v_mfma_f32_16x16x32_bf16 v[88:91], v[120:123], v[160:163], v[88:91]
    v_mfma_f32_16x16x32_bf16 v[92:95], v[124:127], v[160:163], v[92:95]
    ds_read_b128 v[144:147], v22 offset:8192
    s_waitcnt lgkmcnt(8)
    v_mfma_f32_16x16x32_bf16 v[96:99], v[120:123], v[164:167], v[96:99]
    v_mfma_f32_16x16x32_bf16 v[100:103], v[124:127], v[164:167], v[100:103]
    v_dot2c_f32_bf16 v214, s33, v164
    v_dot2c_f32_bf16 v214, s33, v165
    v_dot2c_f32_bf16 v214, s33, v166
    v_dot2c_f32_bf16 v214, s33, v167
    ds_read_b128 v[148:151], v22 offset:10240
    s_waitcnt lgkmcnt(8)
    v_mfma_f32_16x16x32_bf16 v[104:107], v[120:123], v[168:171], v[104:107]
    v_mfma_f32_16x16x32_bf16 v[108:111], v[124:127], v[168:171], v[108:111]
    s_add_u32 s32, s32, 1
    s_cmp_lt_u32 s32, 8
    s_cbranch_scc1 g1_loop_11_1
    s_branch g1_post_11
g1_loop_11_2:
    ds_read_b128 v[152:155], v22 offset:12288
    s_waitcnt lgkmcnt(6)
    v_mfma_f32_16x16x32_bf16 v[24:27], v[112:115], v[128:131], v[24:27]
    v_mfma_f32_16x16x32_bf16 v[28:31], v[116:119], v[128:131], v[28:31]
    v_dot2c_f32_bf16 v216, s33, v112
    v_dot2c_f32_bf16 v217, v112, v112
    ds_read_b128 v[156:159], v22 offset:14336
    s_waitcnt lgkmcnt(6)
    v_mfma_f32_16x16x32_bf16 v[32:35], v[112:115], v[132:135], v[32:35]
    v_mfma_f32_16x16x32_bf16 v[36:39], v[116:119], v[132:135], v[36:39]
    v_dot2c_f32_bf16 v216, s33, v113
    v_dot2c_f32_bf16 v217, v113, v113
    ds_read_b128 v[160:163], v22 offset:16384
    s_waitcnt lgkmcnt(6)
    v_mfma_f32_16x16x32_bf16 v[40:43], v[112:115], v[136:139], v[40:43]
    v_mfma_f32_16x16x32_bf16 v[44:47], v[116:119], v[136:139], v[44:47]
    v_dot2c_f32_bf16 v212, s33, v136
    v_dot2c_f32_bf16 v212, s33, v137
    v_dot2c_f32_bf16 v212, s33, v138
    v_dot2c_f32_bf16 v212, s33, v139
    v_dot2c_f32_bf16 v216, s33, v114
    v_dot2c_f32_bf16 v217, v114, v114
    ds_read_b128 v[164:167], v22 offset:18432
    s_waitcnt lgkmcnt(6)
    v_mfma_f32_16x16x32_bf16 v[48:51], v[112:115], v[140:143], v[48:51]
    v_mfma_f32_16x16x32_bf16 v[52:55], v[116:119], v[140:143], v[52:55]
    v_dot2c_f32_bf16 v216, s33, v115
    v_dot2c_f32_bf16 v217, v115, v115
    ds_read_b128 v[168:171], v22 offset:20480
    s_waitcnt lgkmcnt(6)
    v_mfma_f32_16x16x32_bf16 v[56:59], v[112:115], v[144:147], v[56:59]
    v_mfma_f32_16x16x32_bf16 v[60:63], v[116:119], v[144:147], v[60:63]
    v_dot2c_f32_bf16 v218, s33, v116
    v_dot2c_f32_bf16 v219, v116, v116
    ds_read_b128 v[120:123], v21
    ds_read_b128 v[124:127], v21 offset:2048
    ds_read_b128 v[128:131], v23 offset:0
    s_waitcnt lgkmcnt(8)
    v_mfma_f32_16x16x32_bf16 v[64:67], v[112:115], v[148:151], v[64:67]
    v_mfma_f32_16x16x32_bf16 v[68:71], v[116:119], v[148:151], v[68:71]
    v_dot2c_f32_bf16 v218, s33, v117
    v_dot2c_f32_bf16 v219, v117, v117
    ds_read_b128 v[132:135], v23 offset:2048
    s_waitcnt lgkmcnt(8)
    v_mfma_f32_16x16x32_bf16 v[72:75], v[112:115], v[152:155], v[72:75]
    v_mfma_f32_16x16x32_bf16 v[76:79], v[116:119], v[152:155], v[76:79]
    v_dot2c_f32_bf16 v213, s33, v152
    v_dot2c_f32_bf16 v213, s33, v153
    v_dot2c_f32_bf16 v213, s33, v154
    v_dot2c_f32_bf16 v213, s33, v155
    v_dot2c_f32_bf16 v218, s33, v118
    v_dot2c_f32_bf16 v219, v118, v118
    ds_read_b128 v[136:139], v23 offset:4096
    s_waitcnt lgkmcnt(8)
    v_mfma_f32_16x16x32_bf16 v[80:83], v[112:115], v[156:159], v[80:83]
    v_mfma_f32_16x16x32_bf16 v[84:87], v[116:119], v[156:159], v[84:87]
    v_dot2c_f32_bf16 v218, s33, v119
    v_dot2c_f32_bf16 v219, v119, v119
    ds_read_b128 v[140:143], v23 offset:6144
    s_waitcnt lgkmcnt(8)
    v_mfma_f32_16x16x32_bf16 v[88:91], v[112:115], v[160:163], v[88:91]
    v_mfma_f32_16x16x32_bf16 v[92:95], v[116:119], v[160:163], v[92:95]
    ds_read_b128 v[144:147], v23 offset:8192
    s_waitcnt lgkmcnt(8)
    v_mfma_f32_16x16x32_bf16 v[96:99], v[112:115], v[164:167], v[96:99]
    v_mfma_f32_16x16x32_bf16 v[100:103], v[116:119], v[164:167], v[100:103]
    ds_read_b128 v[148:151], v23 offset:10240
    s_waitcnt lgkmcnt(8)
    v_mfma_f32_16x16x32_bf16 v[104:107], v[112:115], v[168:171], v[104:107]
    v_mfma_f32_16x16x32_bf16 v[108:111], v[116:119], v[168:171], v[108:111]
    v_dot2c_f32_bf16 v214, s33, v168
    v_dot2c_f32_bf16 v214, s33, v169
    v_dot2c_f32_bf16 v214, s33, v170
    v_dot2c_f32_bf16 v214, s33, v171
    ds_read_b128 v[152:155], v23 offset:12288
    s_waitcnt lgkmcnt(6)
    v_mfma_f32_16x16x32_bf16 v[24:27], v[120:123], v[128:131], v[24:27]
    v_mfma_f32_16x16x32_bf16 v[28:31], v[124:127], v[128:131], v[28:31]
    v_dot2c_f32_bf16 v216, s33, v120
    v_dot2c_f32_bf16 v217, v120, v120
    ds_read_b128 v[156:159], v23 offset:14336
    s_waitcnt lgkmcnt(6)
    v_mfma_f32_16x16x32_bf16 v[32:35], v[120:123], v[132:135], v[32:35]
    v_mfma_f32_16x16x32_bf16 v[36:39], v[124:127], v[132:135], v[36:39]
    v_dot2c_f32_bf16 v216, s33, v121
    v_dot2c_f32_bf16 v217, v121, v121
    ds_read_b128 v[160:163], v23 offset:16384
    s_waitcnt lgkmcnt(6)
    v_mfma_f32_16x16x32_bf16 v[40:43], v[120:123], v[136:139], v[40:43]
    v_mfma_f32_16x16x32_bf16 v[44:47], v[124:127], v[136:139], v[44:47]
    v_dot2c_f32_bf16 v212, s33, v136
    v_dot2c_f32_bf16 v212, s33, v137
    v_dot2c_f32_bf16 v212, s33, v138
    v_dot2c_f32_bf16 v212, s33, v139
    v_dot2c_f32_bf16 v216, s33, v122
    v_dot2c_f32_bf16 v217, v122, v122
    ds_read_b128 v[164:167], v23 offset:18432
    s_waitcnt lgkmcnt(6)
    v_mfma_f32_16x16x32_bf16 v[48:51], v[120:123], v[140:143], v[48:51]
    v_mfma_f32_16x16x32_bf16 v[52:55], v[124:127], v[140:143], v[52:55]
    v_dot2c_f32_bf16 v216, s33, v123
    v_dot2c_f32_bf16 v217, v123, v123
    ds_read_b128 v[168:171], v23 offset:20480
    s_waitcnt lgkmcnt(6)
    v_mfma_f32_16x16x32_bf16 v[56:59], v[120:123], v[144:147], v[56:59]
    v_mfma_f32_16x16x32_bf16 v[60:63], v[124:127], v[144:147], v[60:63]
    v_dot2c_f32_bf16 v218, s33, v124
    v_dot2c_f32_bf16 v219, v124, v124
    s_barrier
    s_add_u32 s28, s28, 38912
    s_cmp_ge_u32 s28, 155648
    s_cselect_b32 s34, 155648, 0
    s_cselect_b32 s28, 0, s28
    s_sub_u32 s34, 38912, s34
    v_add_u32 v20, s34, v20
    v_add_u32 v21, s34, v21
    v_add_u32 v22, s34, v22
    v_add_u32 v23, s34, v23
    ds_read_b128 v[112:115], v20
    ds_read_b128 v[116:119], v20 offset:2048
    ds_read_b128 v[128:131], v22 offset:0
    s_waitcnt lgkmcnt(8)
    v_mfma_f32_16x16x32_bf16 v[64:67], v[120:123], v[148:151], v[64:67]
    v_mfma_f32_16x16x32_bf16 v[68:71], v[124:127], v[148:151], v[68:71]
    v_dot2c_f32_bf16 v218, s33, v125
    v_dot2c_f32_bf16 v219, v125, v125
    ds_read_b128 v[132:135], v22 offset:2048
    s_waitcnt lgkmcnt(8)
    v_mfma_f32_16x16x32_bf16 v[72:75], v[120:123], v[152:155], v[72:75]
    v_mfma_f32_16x16x32_bf16 v[76:79], v[124:127], v[152:155], v[76:79]
    v_dot2c_f32_bf16 v213, s33, v152
    v_dot2c_f32_bf16 v213, s33, v153
    v_dot2c_f32_bf16 v213, s33, v154
    v_dot2c_f32_bf16 v213, s33, v155
    v_dot2c_f32_bf16 v218, s33, v126
    v_dot2c_f32_bf16 v219, v126, v126
    ds_read_b128 v[136:139], v22 offset:4096
    s_waitcnt lgkmcnt(8)
    v_mfma_f32_16x16x32_bf16 v[80:83], v[120:123], v[156:159], v[80:83]
    v_mfma_f32_16x16x32_bf16 v[84:87], v[124:127], v[156:159], v[84:87]
    v_dot2c_f32_bf16 v218, s33, v127
    v_dot2c_f32_bf16 v219, v127, v127
    ds_read_b128 v[140:143], v22 offset:6144
    s_waitcnt lgkmcnt(8)
    v_mfma_f32_16x16x32_bf16 v[88:91], v[120:123], v[160:163], v[88:91]
    v_mfma_f32_16x16x32_bf16 v[92:95], v[124:127], v[160:163], v[92:95]
    ds_read_b128 v[144:147], v22 offset:8192
    s_waitcnt lgkmcnt(8)
    v_mfma_f32_16x16x32_bf16 v[96:99], v[120:123], v[164:167], v[96:99]
    v_mfma_f32_16x16x32_bf16 v[100:103], v[124:127], v[164:167], v[100:103]
    ds_read_b128 v[148:151], v22 offset:10240
    s_waitcnt lgkmcnt(8)
    v_mfma_f32_16x16x32_bf16 v[104:107], v[120:123], v[168:171], v[104:107]
    v_mfma_f32_16x16x32_bf16 v[108:111], v[124:127], v[168:171], v[108:111]
    v_dot2c_f32_bf16 v214, s33, v168
    v_dot2c_f32_bf16 v214, s33, v169
    v_dot2c_f32_bf16 v214, s33, v170
    v_dot2c_f32_bf16 v214, s33, v171
    s_add_u32 s32, s32, 1
    s_cmp_lt_u32 s32, 8
    s_cbranch_scc1 g1_loop_11_2
    s_branch g1_post_11
g1_loop_11_3:
    ds_read_b128 v[152:155], v22 offset:12288
    s_waitcnt lgkmcnt(6)
    v_mfma_f32_16x16x32_bf16 v[24:27], v[112:115], v[128:131], v[24:27]
    v_mfma_f32_16x16x32_bf16 v[28:31], v[116:119], v[128:131], v[28:31]
    v_dot2c_f32_bf16 v216, s33, v112
    v_dot2c_f32_bf16 v217, v112, v112
    ds_read_b128 v[156:159], v22 offset:14336
    s_waitcnt lgkmcnt(6)
    v_mfma_f32_16x16x32_bf16 v[32:35], v[112:115], v[132:135], v[32:35]
    v_mfma_f32_16x16x32_bf16 v[36:39], v[116:119], v[132:135], v[36:39]
    v_dot2c_f32_bf16 v216, s33, v113
    v_dot2c_f32_bf16 v217, v113, v113
    ds_read_b128 v[160:163], v22 offset:16384
    s_waitcnt lgkmcnt(6)
    v_mfma_f32_16x16x32_bf16 v[40:43], v[112:115], v[136:139], v[40:43]
    v_mfma_f32_16x16x32_bf16 v[44:47], v[116:119], v[136:139], v[44:47]
    v_dot2c_f32_bf16 v216, s33, v114
    v_dot2c_f32_bf16 v217, v114, v114
    ds_read_b128 v[164:167], v22 offset:18432
    s_waitcnt lgkmcnt(6)
    v_mfma_f32_16x16x32_bf16 v[48:51], v[112:115], v[140:143], v[48:51]
    v_mfma_f32_16x16x32_bf16 v[52:55], v[116:119], v[140:143], v[52:55]
    v_dot2c_f32_bf16 v212, s33, v140
    v_dot2c_f32_bf16 v212, s33, v141
    v_dot2c_f32_bf16 v212, s33, v142
    v_dot2c_f32_bf16 v212, s33, v143
    v_dot2c_f32_bf16 v216, s33, v115
    v_dot2c_f32_bf16 v217, v115, v115
    ds_read_b128 v[168:171], v22 offset:20480
    s_waitcnt lgkmcnt(6)
    v_mfma_f32_16x16x32_bf16 v[56:59], v[112:115], v[144:147], v[56:59]
    v_mfma_f32_16x16x32_bf16 v[60:63], v[116:119], v[144:147], v[60:63]
    v_dot2c_f32_bf16 v218, s33, v116
    v_dot2c_f32_bf16 v219, v116, v116
    ds_read_b128 v[120:123], v21
    ds_read_b128 v[124:127], v21 offset:2048
    ds_read_b128 v[128:131], v23 offset:0
    s_waitcnt lgkmcnt(8)
    v_mfma_f32_16x16x32_bf16 v[64:67], v[112:115], v[148:151], v[64:67]
    v_mfma_f32_16x16x32_bf16 v[68:71], v[116:119], v[148:151], v[68:71]
    v_dot2c_f32_bf16 v218, s33, v117
    v_dot2c_f32_bf16 v219, v117, v117
    ds_read_b128 v[132:135], v23 offset:2048
    s_waitcnt lgkmcnt(8)
    v_mfma_f32_16x16x32_bf16 v[72:75], v[112:115], v[152:155], v[72:75]
    v_mfma_f32_16x16x32_bf16 v[76:79], v[116:119], v[152:155], v[76:79]
    v_dot2c_f32_bf16 v218, s33, v118
    v_dot2c_f32_bf16 v219, v118, v118
    ds_read_b128 v[136:139], v23 offset:4096
    s_waitcnt lgkmcnt(8)
    v_mfma_f32_16x16x32_bf16 v[80:83], v[112:115], v[156:159], v[80:83]
    v_mfma_f32_16x16x32_bf16 v[84:87], v[116:119], v[156:159], v[84:87]
    v_dot2c_f32_bf16 v213, s33, v156
    v_dot2c_f32_bf16 v213, s33, v157
    v_dot2c_f32_bf16 v213, s33, v158
    v_dot2c_f32_bf16 v213, s33, v159
    v_dot2c_f32_bf16 v218, s33, v119
    v_dot2c_f32_bf16 v219, v119, v119
    ds_read_b128 v[140:143], v23 offset:6144
    s_waitcnt lgkmcnt(8)
    v_mfma_f32_16x16x32_bf16 v[88:91], v[112:115], v[160:163], v[88:91]
    v_mfma_f32_16x16x32_bf16 v[92:95], v[116:119], v[160:163], v[92:95]
    ds_read_b128 v[144:147], v23 offset:8192
    s_waitcnt lgkmcnt(8)
    v_mfma_f32_16x16x32_bf16 v[96:99], v[112:115], v[164:167], v[96:99]
    v_mfma_f32_16x16x32_bf16 v[100:103], v[116:119], v[164:167], v[100:103]
    ds_read_b128 v[148:151], v23 offset:10240
    s_waitcnt lgkmcnt(8)
    v_mfma_f32_16x16x32_bf16 v[104:107], v[112:115], v[168:171], v[104:107]
    v_mfma_f32_16x16x32_bf16 v[108:111], v[116:119], v[168:171], v[108:111]
    ds_read_b128 v[152:155], v23 offset:12288
    s_waitcnt lgkmcnt(6)
    v_mfma_f32_16x16x32_bf16 v[24:27], v[120:123], v[128:131], v[24:27]
    v_mfma_f32_16x16x32_bf16 v[28:31], v[124:127], v[128:131], v[28:31]
    v_dot2c_f32_bf16 v216, s33, v120
    v_dot2c_f32_bf16 v217, v120, v120
    ds_read_b128 v[156:159], v23 offset:14336
    s_waitcnt lgkmcnt(6)
    v_mfma_f32_16x16x32_bf16 v[32:35], v[120:123], v[132:135], v[32:35]
    v_mfma_f32_16x16x32_bf16 v[36:39], v[124:127], v[132:135], v[36:39]
    v_dot2c_f32_bf16 v216, s33, v121
    v_dot2c_f32_bf16 v217, v121, v121
    ds_read_b128 v[160:163], v23 offset:16384
    s_waitcnt lgkmcnt(6)
    v_mfma_f32_16x16x32_bf16 v[40:43], v[120:123], v[136:139], v[40:43]
    v_mfma_f32_16x16x32_bf16 v[44:47], v[124:127], v[136:139], v[44:47]
    v_dot2c_f32_bf16 v216, s33, v122
    v_dot2c_f32_bf16 v217, v122, v122
    ds_read_b128 v[164:167], v23 offset:18432
    s_waitcnt lgkmcnt(6)
    v_mfma_f32_16x16x32_bf16 v[48:51], v[120:123], v[140:143], v[48:51]
    v_mfma_f32_16x16x32_bf16 v[52:55], v[124:127], v[140:143], v[52:55]
    v_dot2c_f32_bf16 v212, s33, v140
    v_dot2c_f32_bf16 v212, s33, v141
    v_dot2c_f32_bf16 v212, s33, v142
    v_dot2c_f32_bf16 v212, s33, v143
    v_dot2c_f32_bf16 v216, s33, v123
    v_dot2c_f32_bf16 v217, v123, v123
    ds_read_b128 v[168:171], v23 offset:20480
    s_waitcnt lgkmcnt(6)
    v_mfma_f32_16x16x32_bf16 v[56:59], v[120:123], v[144:147], v[56:59]
    v_mfma_f32_16x16x32_bf16 v[60:63], v[124:127], v[144:147], v[60:63]
    v_dot2c_f32_bf16 v218, s33, v124
    v_dot2c_f32_bf16 v219, v124, v124
    s_barrier
    s_add_u32 s28, s28, 38912
    s_cmp_ge_u32 s28, 155648
    s_cselect_b32 s34, 155648, 0
    s_cselect_b32 s28, 0, s28
    s_sub_u32 s34, 38912, s34
    v_add_u32 v20, s34, v20
    v_add_u32 v21, s34, v21
    v_add_u32 v22, s34, v22
    v_add_u32 v23, s34, v23
    ds_read_b128 v[112:115], v20
    ds_read_b128 v[116:119], v20 offset:2048
    ds_read_b128 v[128:131], v22 offset:0
    s_waitcnt lgkmcnt(8)
    v_mfma_f32_16x16x32_bf16 v[64:67], v[120:123], v[148:151], v[64:67]
    v_mfma_f32_16x16x32_bf16 v[68:71], v[124:127], v[148:151], v[68:71]
    v_dot2c_f32_bf16 v218, s33, v125
    v_dot2c_f32_bf16 v219, v125, v125
    ds_read_b128 v[132:135], v22 offset:2048
    s_waitcnt lgkmcnt(8)
    v_mfma_f32_16x16x32_bf16 v[72:75], v[120:123], v[152:155], v[72:75]
    v_mfma_f32_16x16x32_bf16 v[76:79], v[124:127], v[152:155], v[76:79]
    v_dot2c_f32_bf16 v218, s33, v126
    v_dot2c_f32_bf16 v219, v126, v126
    ds_read_b128 v[136:139], v22 offset:4096
    s_waitcnt lgkmcnt(8)
    v_mfma_f32_16x16x32_bf16 v[80:83], v[120:123], v[156:159], v[80:83]
    v_mfma_f32_16x16x32_bf16 v[84:87], v[124:127], v[156:159], v[84:87]
    v_dot2c_f32_bf16 v213, s33, v156
    v_dot2c_f32_bf16 v213, s33, v157
    v_dot2c_f32_bf16 v213, s33, v158
    v_dot2c_f32_bf16 v213, s33, v159
    v_dot2c_f32_bf16 v218, s33, v127
    v_dot2c_f32_bf16 v219, v127, v127
    ds_read_b128 v[140:143], v22 offset:6144
    s_waitcnt lgkmcnt(8)
    v_mfma_f32_16x16x32_bf16 v[88:91], v[120:123], v[160:163], v[88:91]
    v_mfma_f32_16x16x32_bf16 v[92:95], v[124:127], v[160:163], v[92:95]
    ds_read_b128 v[144:147], v22 offset:8192
    s_waitcnt lgkmcnt(8)
    v_mfma_f32_16x16x32_bf16 v[96:99], v[120:123], v[164:167], v[96:99]
    v_mfma_f32_16x16x32_bf16 v[100:103], v[124:127], v[164:167], v[100:103]
    ds_read_b128 v[148:151], v22 offset:10240
    s_waitcnt lgkmcnt(8)
    v_mfma_f32_16x16x32_bf16 v[104:107], v[120:123], v[168:171], v[104:107]
    v_mfma_f32_16x16x32_bf16 v[108:111], v[124:127], v[168:171], v[108:111]
    s_add_u32 s32, s32, 1
    s_cmp_lt_u32 s32, 8
    s_cbranch_scc1 g1_loop_11_3
g1_post_11:
    s_waitcnt lgkmcnt(0)
    s_nop 3
    v_xor_b32 v8, 16, v2
    v_lshlrev_b32 v8, 2, v8
    v_xor_b32 v9, 32, v2
    v_lshlrev_b32 v9, 2, v9
    ds_bpermute_b32 v220, v8, v216
    ds_bpermute_b32 v221, v8, v217
    ds_bpermute_b32 v222, v8, v218
    ds_bpermute_b32 v223, v8, v219
    s_waitcnt lgkmcnt(0)
    v_add_f32 v216, v216, v220
    v_add_f32 v217, v217, v221
    v_add_f32 v218, v218, v222
    v_add_f32 v219, v219, v223
    ds_bpermute_b32 v220, v9, v216
    ds_bpermute_b32 v221, v9, v217
    ds_bpermute_b32 v222, v9, v218
    ds_bpermute_b32 v223, v9, v219
    s_waitcnt lgkmcnt(0)
    v_add_f32 v216, v216, v220
    v_add_f32 v217, v217, v221
    v_add_f32 v218, v218, v222
    v_add_f32 v219, v219, v223
    v_mul_f32 v216, 0x3b000000, v216
    v_mul_f32 v217, 0x3b000000, v217
    v_fma_f32 v217, -v216, v216, v217
    v_max_f32 v217, 0, v217
    v_cvt_pk_bf16_f32 v220, v216, v217
    v_lshlrev_b32 v216, 16, v220
    v_and_b32 v217, 0xffff0000, v220
    v_add_f32 v217, 0x3727c5ac, v217
    v_cvt_pk_bf16_f32 v220, v217, v217
    v_lshlrev_b32 v217, 16, v220
    v_sqrt_f32 v217, v217
    s_nop 1
    v_cvt_pk_bf16_f32 v220, v217, v217
    v_lshlrev_b32 v217, 16, v220
    v_rcp_f32 v217, v217
    s_nop 1
    v_mul_f32 v218, 0x3b000000, v218
    v_mul_f32 v219, 0x3b000000, v219
    v_fma_f32 v219, -v218, v218, v219
    v_max_f32 v219, 0, v219
    v_cvt_pk_bf16_f32 v220, v218, v219
    v_lshlrev_b32 v218, 16, v220
    v_and_b32 v219, 0xffff0000, v220
    v_add_f32 v219, 0x3727c5ac, v219
    v_cvt_pk_bf16_f32 v220, v219, v219
    v_lshlrev_b32 v219, 16, v220
    v_sqrt_f32 v219, v219
    s_nop 1
    v_cvt_pk_bf16_f32 v220, v219, v219
    v_lshlrev_b32 v219, 16, v220
    v_rcp_f32 v219, v219
    s_nop 1
    s_lshl_b32 s22, s18, 8
    s_add_u32 s22, s22, 155648
    v_lshlrev_b32 v8, 3, v5
    v_add_u32 v8, s22, v8
    ds_write_b64 v8, v[216:217]
    ds_write_b64 v8, v[218:219] offset:128
    s_nop 3
    s_lshl_b32 s34, s18, 6
    s_add_u32 s34, s34, 156672
    v_lshlrev_b32 v8, 2, v5
    v_add_u32 v8, s34, v8
    ds_add_f32 v8, v212
    ds_add_f32 v8, v213 offset:256
    s_cmp_eq_u32 s18, 3
    s_cbranch_scc1 g1_ws3_11
    ds_add_f32 v8, v214 offset:512
g1_ws3_11:
    s_waitcnt lgkmcnt(0)
    v_mov_b32 v8, 157440
    v_mov_b32 v9, 1
    s_mov_b64 s[34:35], exec
    s_mov_b64 exec, 1
    ds_add_u32 v8, v9
    s_mov_b64 exec, s[34:35]
    s_add_u32 s8, s6, 0x700000
    s_addc_u32 s9, s7, 0
    s_and_b32 s9, s9, 0xffff
    s_mov_b32 s10, 0x400000
    s_mov_b32 s11, 0x20000
    s_add_u32 s12, s6, 0xb00000
    s_addc_u32 s13, s7, 0
    s_and_b32 s13, s13, 0xffff
    s_mov_b32 s14, 0x800000
    s_mov_b32 s15, 0x20000
    s_mov_b32 s36, s4
    s_mov_b32 s37, s5
    s_and_b32 s37, s37, 0xffff
    s_mov_b32 s38, 0xe00
    s_mov_b32 s39, 0x20000
    s_lshl_b32 s20, s16, 7
    s_lshl_b32 s21, s18, 5
    s_add_u32 s20, s20, s21
    s_mul_i32 s21, s17, 176
    v_mul_u32_u24 v7, 272, v5
    v_lshl_add_u32 v7, v6, 3, v7
    s_lshl_b32 s22, s18, 6
    v_add_u32 v7, s22, v7
    s_lshl_b32 s22, s18, 8
    s_add_u32 s22, s22, 155648
    v_lshlrev_b32 v10, 5, v6
    v_add_u32 v10, s22, v10
    v_mov_b32 v8, 157440
g1_poll_11:
    ds_read_b32 v9, v8
    s_waitcnt lgkmcnt(0)
    v_readfirstlane_b32 s22, v9
    s_nop 1
    s_cmp_lt_u32 s22, 4
    s_cbranch_scc1 g1_poll_11
    ds_read_b128 v[160:163], v10 offset:0
    ds_read_b128 v[164:167], v10 offset:16
    ds_read_b128 v[176:179], v10 offset:128
    ds_read_b128 v[180:183], v10 offset:144
    v_lshlrev_b32 v8, 2, v5
    v_add_u32 v8, 156672, v8
    ds_read_b32 v196, v8 offset:0
    ds_read_b32 v197, v8 offset:64
    ds_read_b32 v198, v8 offset:128
    ds_read_b32 v199, v8 offset:192
    ds_read_b32 v200, v8 offset:256
    ds_read_b32 v201, v8 offset:320
    ds_read_b32 v202, v8 offset:384
    ds_read_b32 v203, v8 offset:448
    ds_read_b32 v204, v8 offset:512
    ds_read_b32 v205, v8 offset:576
    ds_read_b32 v206, v8 offset:640
    v_lshlrev_b32 v9, 4, v6
    v_add_u32 v9, 156672, v9
    s_waitcnt lgkmcnt(0)
    s_add_u32 s22, s21, 0
    s_cmp_ge_u32 s22, 512
    s_cselect_b32 s23, 0x80008000, 0
    v_fma_f32 v24, -v160, v196, v24
    v_mul_f32 v24, v161, v24
    v_fma_f32 v25, -v162, v196, v25
    v_mul_f32 v25, v163, v25
    v_fma_f32 v26, -v164, v196, v26
    v_mul_f32 v26, v165, v26
    v_fma_f32 v27, -v166, v196, v27
    v_mul_f32 v27, v167, v27
    v_cvt_pk_bf16_f32 v24, v24, v25
    v_cvt_pk_bf16_f32 v25, v26, v27
    v_xor_b32 v24, s23, v24
    v_xor_b32 v25, s23, v25
    ds_write_b64 v7, v[24:25] offset:0
    v_fma_f32 v28, -v176, v196, v28
    v_mul_f32 v28, v177, v28
    v_fma_f32 v29, -v178, v196, v29
    v_mul_f32 v29, v179, v29
    v_fma_f32 v30, -v180, v196, v30
    v_mul_f32 v30, v181, v30
    v_fma_f32 v31, -v182, v196, v31
    v_mul_f32 v31, v183, v31
    v_cvt_pk_bf16_f32 v28, v28, v29
    v_cvt_pk_bf16_f32 v29, v30, v31
    v_xor_b32 v28, s23, v28
    v_xor_b32 v29, s23, v29
    ds_write_b64 v7, v[28:29] offset:32
    s_add_u32 s22, s21, 16
    s_cmp_ge_u32 s22, 512
    s_cselect_b32 s23, 0x80008000, 0
    v_fma_f32 v32, -v160, v197, v32
    v_mul_f32 v32, v161, v32
    v_fma_f32 v33, -v162, v197, v33
    v_mul_f32 v33, v163, v33
    v_fma_f32 v34, -v164, v197, v34
    v_mul_f32 v34, v165, v34
    v_fma_f32 v35, -v166, v197, v35
    v_mul_f32 v35, v167, v35
    v_cvt_pk_bf16_f32 v32, v32, v33
    v_cvt_pk_bf16_f32 v33, v34, v35
    v_xor_b32 v32, s23, v32
    v_xor_b32 v33, s23, v33
    ds_write_b64 v7, v[32:33] offset:4352
    v_fma_f32 v36, -v176, v197, v36
    v_mul_f32 v36, v177, v36
    v_fma_f32 v37, -v178, v197, v37
    v_mul_f32 v37, v179, v37
    v_fma_f32 v38, -v180, v197, v38
    v_mul_f32 v38, v181, v38
    v_fma_f32 v39, -v182, v197, v39
    v_mul_f32 v39, v183, v39
    v_cvt_pk_bf16_f32 v36, v36, v37
    v_cvt_pk_bf16_f32 v37, v38, v39
    v_xor_b32 v36, s23, v36
    v_xor_b32 v37, s23, v37
    ds_write_b64 v7, v[36:37] offset:4384
    s_add_u32 s22, s21, 32
    s_cmp_ge_u32 s22, 512
    s_cselect_b32 s23, 0x80008000, 0
    v_fma_f32 v40, -v160, v198, v40
    v_mul_f32 v40, v161, v40
    v_fma_f32 v41, -v162, v198, v41
    v_mul_f32 v41, v163, v41
    v_fma_f32 v42, -v164, v198, v42
    v_mul_f32 v42, v165, v42
    v_fma_f32 v43, -v166, v198, v43
    v_mul_f32 v43, v167, v43
    v_cvt_pk_bf16_f32 v40, v40, v41
    v_cvt_pk_bf16_f32 v41, v42, v43
    v_xor_b32 v40, s23, v40
    v_xor_b32 v41, s23, v41
    ds_write_b64 v7, v[40:41] offset:8704
    v_fma_f32 v44, -v176, v198, v44
    v_mul_f32 v44, v177, v44
    v_fma_f32 v45, -v178, v198, v45
    v_mul_f32 v45, v179, v45
    v_fma_f32 v46, -v180, v198, v46
    v_mul_f32 v46, v181, v46
    v_fma_f32 v47, -v182, v198, v47
    v_mul_f32 v47, v183, v47
    v_cvt_pk_bf16_f32 v44, v44, v45
    v_cvt_pk_bf16_f32 v45, v46, v47
    v_xor_b32 v44, s23, v44
    v_xor_b32 v45, s23, v45
    ds_write_b64 v7, v[44:45] offset:8736
    s_add_u32 s22, s21, 48
    s_cmp_ge_u32 s22, 512
    s_cselect_b32 s23, 0x80008000, 0
    v_fma_f32 v48, -v160, v199, v48
    v_mul_f32 v48, v161, v48
    v_fma_f32 v49, -v162, v199, v49
    v_mul_f32 v49, v163, v49
    v_fma_f32 v50, -v164, v199, v50
    v_mul_f32 v50, v165, v50
    v_fma_f32 v51, -v166, v199, v51
    v_mul_f32 v51, v167, v51
    v_cvt_pk_bf16_f32 v48, v48, v49
    v_cvt_pk_bf16_f32 v49, v50, v51
    v_xor_b32 v48, s23, v48
    v_xor_b32 v49, s23, v49
    ds_write_b64 v7, v[48:49] offset:13056
    v_fma_f32 v52, -v176, v199, v52
    v_mul_f32 v52, v177, v52
    v_fma_f32 v53, -v178, v199, v53
    v_mul_f32 v53, v179, v53
    v_fma_f32 v54, -v180, v199, v54
    v_mul_f32 v54, v181, v54
    v_fma_f32 v55, -v182, v199, v55
    v_mul_f32 v55, v183, v55
    v_cvt_pk_bf16_f32 v52, v52, v53
    v_cvt_pk_bf16_f32 v53, v54, v55
    v_xor_b32 v52, s23, v52
    v_xor_b32 v53, s23, v53
    ds_write_b64 v7, v[52:53] offset:13088
    s_add_u32 s22, s21, 64
    s_cmp_ge_u32 s22, 512
    s_cselect_b32 s23, 0x80008000, 0
    v_fma_f32 v56, -v160, v200, v56
    v_mul_f32 v56, v161, v56
    v_fma_f32 v57, -v162, v200, v57
    v_mul_f32 v57, v163, v57
    v_fma_f32 v58, -v164, v200, v58
    v_mul_f32 v58, v165, v58
    v_fma_f32 v59, -v166, v200, v59
    v_mul_f32 v59, v167, v59
    v_cvt_pk_bf16_f32 v56, v56, v57
    v_cvt_pk_bf16_f32 v57, v58, v59
    v_xor_b32 v56, s23, v56
    v_xor_b32 v57, s23, v57
    ds_write_b64 v7, v[56:57] offset:17408
    v_fma_f32 v60, -v176, v200, v60
    v_mul_f32 v60, v177, v60
    v_fma_f32 v61, -v178, v200, v61
    v_mul_f32 v61, v179, v61
    v_fma_f32 v62, -v180, v200, v62
    v_mul_f32 v62, v181, v62
    v_fma_f32 v63, -v182, v200, v63
    v_mul_f32 v63, v183, v63
    v_cvt_pk_bf16_f32 v60, v60, v61
    v_cvt_pk_bf16_f32 v61, v62, v63
    v_xor_b32 v60, s23, v60
    v_xor_b32 v61, s23, v61
    ds_write_b64 v7, v[60:61] offset:17440
    s_add_u32 s22, s21, 80
    s_cmp_ge_u32 s22, 512
    s_cselect_b32 s23, 0x80008000, 0
    v_fma_f32 v64, -v160, v201, v64
    v_mul_f32 v64, v161, v64
    v_fma_f32 v65, -v162, v201, v65
    v_mul_f32 v65, v163, v65
    v_fma_f32 v66, -v164, v201, v66
    v_mul_f32 v66, v165, v66
    v_fma_f32 v67, -v166, v201, v67
    v_mul_f32 v67, v167, v67
    v_cvt_pk_bf16_f32 v64, v64, v65
    v_cvt_pk_bf16_f32 v65, v66, v67
    v_xor_b32 v64, s23, v64
    v_xor_b32 v65, s23, v65
    ds_write_b64 v7, v[64:65] offset:21760
    v_fma_f32 v68, -v176, v201, v68
    v_mul_f32 v68, v177, v68
    v_fma_f32 v69, -v178, v201, v69
    v_mul_f32 v69, v179, v69
    v_fma_f32 v70, -v180, v201, v70
    v_mul_f32 v70, v181, v70
    v_fma_f32 v71, -v182, v201, v71
    v_mul_f32 v71, v183, v71
    v_cvt_pk_bf16_f32 v68, v68, v69
    v_cvt_pk_bf16_f32 v69, v70, v71
    v_xor_b32 v68, s23, v68
    v_xor_b32 v69, s23, v69
    ds_write_b64 v7, v[68:69] offset:21792
    s_add_u32 s22, s21, 96
    s_cmp_ge_u32 s22, 512
    s_cselect_b32 s23, 0x80008000, 0
    v_fma_f32 v72, -v160, v202, v72
    v_mul_f32 v72, v161, v72
    v_fma_f32 v73, -v162, v202, v73
    v_mul_f32 v73, v163, v73
    v_fma_f32 v74, -v164, v202, v74
    v_mul_f32 v74, v165, v74
    v_fma_f32 v75, -v166, v202, v75
    v_mul_f32 v75, v167, v75
    v_cvt_pk_bf16_f32 v72, v72, v73
    v_cvt_pk_bf16_f32 v73, v74, v75
    v_xor_b32 v72, s23, v72
    v_xor_b32 v73, s23, v73
    ds_write_b64 v7, v[72:73] offset:26112
    v_fma_f32 v76, -v176, v202, v76
    v_mul_f32 v76, v177, v76
    v_fma_f32 v77, -v178, v202, v77
    v_mul_f32 v77, v179, v77
    v_fma_f32 v78, -v180, v202, v78
    v_mul_f32 v78, v181, v78
    v_fma_f32 v79, -v182, v202, v79
    v_mul_f32 v79, v183, v79
    v_cvt_pk_bf16_f32 v76, v76, v77
    v_cvt_pk_bf16_f32 v77, v78, v79
    v_xor_b32 v76, s23, v76
    v_xor_b32 v77, s23, v77
    ds_write_b64 v7, v[76:77] offset:26144
    s_add_u32 s22, s21, 112
    s_cmp_ge_u32 s22, 512
    s_cselect_b32 s23, 0x80008000, 0
    v_fma_f32 v80, -v160, v203, v80
    v_mul_f32 v80, v161, v80
    v_fma_f32 v81, -v162, v203, v81
    v_mul_f32 v81, v163, v81
    v_fma_f32 v82, -v164, v203, v82
    v_mul_f32 v82, v165, v82
    v_fma_f32 v83, -v166, v203, v83
    v_mul_f32 v83, v167, v83
    v_cvt_pk_bf16_f32 v80, v80, v81
    v_cvt_pk_bf16_f32 v81, v82, v83
    v_xor_b32 v80, s23, v80
    v_xor_b32 v81, s23, v81
    ds_write_b64 v7, v[80:81] offset:30464
    v_fma_f32 v84, -v176, v203, v84
    v_mul_f32 v84, v177, v84
    v_fma_f32 v85, -v178, v203, v85
    v_mul_f32 v85, v179, v85
    v_fma_f32 v86, -v180, v203, v86
    v_mul_f32 v86, v181, v86
    v_fma_f32 v87, -v182, v203, v87
    v_mul_f32 v87, v183, v87
    v_cvt_pk_bf16_f32 v84, v84, v85
    v_cvt_pk_bf16_f32 v85, v86, v87
    v_xor_b32 v84, s23, v84
    v_xor_b32 v85, s23, v85
    ds_write_b64 v7, v[84:85] offset:30496
    s_add_u32 s22, s21, 128
    s_cmp_ge_u32 s22, 512
    s_cselect_b32 s23, 0x80008000, 0
    v_fma_f32 v88, -v160, v204, v88
    v_mul_f32 v88, v161, v88
    v_fma_f32 v89, -v162, v204, v89
    v_mul_f32 v89, v163, v89
    v_fma_f32 v90, -v164, v204, v90
    v_mul_f32 v90, v165, v90
    v_fma_f32 v91, -v166, v204, v91
    v_mul_f32 v91, v167, v91
    v_cvt_pk_bf16_f32 v88, v88, v89
    v_cvt_pk_bf16_f32 v89, v90, v91
    v_xor_b32 v88, s23, v88
    v_xor_b32 v89, s23, v89
    ds_write_b64 v7, v[88:89] offset:34816
    v_fma_f32 v92, -v176, v204, v92
    v_mul_f32 v92, v177, v92
    v_fma_f32 v93, -v178, v204, v93
    v_mul_f32 v93, v179, v93
    v_fma_f32 v94, -v180, v204, v94
    v_mul_f32 v94, v181, v94
    v_fma_f32 v95, -v182, v204, v95
    v_mul_f32 v95, v183, v95
    v_cvt_pk_bf16_f32 v92, v92, v93
    v_cvt_pk_bf16_f32 v93, v94, v95
    v_xor_b32 v92, s23, v92
    v_xor_b32 v93, s23, v93
    ds_write_b64 v7, v[92:93] offset:34848
    s_add_u32 s22, s21, 144
    s_cmp_ge_u32 s22, 512
    s_cselect_b32 s23, 0x80008000, 0
    v_fma_f32 v96, -v160, v205, v96
    v_mul_f32 v96, v161, v96
    v_fma_f32 v97, -v162, v205, v97
    v_mul_f32 v97, v163, v97
    v_fma_f32 v98, -v164, v205, v98
    v_mul_f32 v98, v165, v98
    v_fma_f32 v99, -v166, v205, v99
    v_mul_f32 v99, v167, v99
    v_cvt_pk_bf16_f32 v96, v96, v97
    v_cvt_pk_bf16_f32 v97, v98, v99
    v_xor_b32 v96, s23, v96
    v_xor_b32 v97, s23, v97
    ds_write_b64 v7, v[96:97] offset:39168
    v_fma_f32 v100, -v176, v205, v100
    v_mul_f32 v100, v177, v100
    v_fma_f32 v101, -v178, v205, v101
    v_mul_f32 v101, v179, v101
    v_fma_f32 v102, -v180, v205, v102
    v_mul_f32 v102, v181, v102
    v_fma_f32 v103, -v182, v205, v103
    v_mul_f32 v103, v183, v103
    v_cvt_pk_bf16_f32 v100, v100, v101
    v_cvt_pk_bf16_f32 v101, v102, v103
    v_xor_b32 v100, s23, v100
    v_xor_b32 v101, s23, v101
    ds_write_b64 v7, v[100:101] offset:39200
    s_add_u32 s22, s21, 160
    s_cmp_ge_u32 s22, 512
    s_cselect_b32 s23, 0x80008000, 0
    v_fma_f32 v104, -v160, v206, v104
    v_mul_f32 v104, v161, v104
    v_fma_f32 v105, -v162, v206, v105
    v_mul_f32 v105, v163, v105
    v_fma_f32 v106, -v164, v206, v106
    v_mul_f32 v106, v165, v106
    v_fma_f32 v107, -v166, v206, v107
    v_mul_f32 v107, v167, v107
    v_cvt_pk_bf16_f32 v104, v104, v105
    v_cvt_pk_bf16_f32 v105, v106, v107
    v_xor_b32 v104, s23, v104
    v_xor_b32 v105, s23, v105
    ds_write_b64 v7, v[104:105] offset:43520
    v_fma_f32 v108, -v176, v206, v108
    v_mul_f32 v108, v177, v108
    v_fma_f32 v109, -v178, v206, v109
    v_mul_f32 v109, v179, v109
    v_fma_f32 v110, -v180, v206, v110
    v_mul_f32 v110, v181, v110
    v_fma_f32 v111, -v182, v206, v111
    v_mul_f32 v111, v183, v111
    v_cvt_pk_bf16_f32 v108, v108, v109
    v_cvt_pk_bf16_f32 v109, v110, v111
    v_xor_b32 v108, s23, v108
    v_xor_b32 v109, s23, v109
    ds_write_b64 v7, v[108:109] offset:43552
    s_waitcnt lgkmcnt(0)
    v_mov_b32 v8, 157696
    v_mov_b32 v10, 1
    s_mov_b64 s[34:35], exec
    s_mov_b64 exec, 1
    ds_add_u32 v8, v10
    s_mov_b64 exec, s[34:35]
    v_mov_b32 v8, 157696
g1_poll2_11:
    ds_read_b32 v9, v8
    s_waitcnt lgkmcnt(0)
    v_readfirstlane_b32 s22, v9
    s_nop 1
    s_cmp_lt_u32 s22, 4
    s_cbranch_scc1 g1_poll2_11
    s_lshl_b32 s22, s18, 6
    v_add_u32 v8, s22, v2
    v_lshrrev_b32 v10, 4, v8
    v_and_b32 v12, 15, v8
    v_mul_u32_u24 v13, 272, v10
    v_lshl_add_u32 v13, v12, 4, v13
    v_add_u32 v10, s21, v10
    v_lshlrev_b32 v10, 12, v10
    v_lshl_add_u32 v10, v12, 4, v10
    s_lshl_b32 s22, s16, 8
    v_add_u32 v10, s22, v10
    ds_read_b128 v[160:163], v13 offset:0
    ds_read_b128 v[164:167], v13 offset:4352
    ds_read_b128 v[168:171], v13 offset:8704
    ds_read_b128 v[172:175], v13 offset:13056
    ds_read_b128 v[176:179], v13 offset:17408
    ds_read_b128 v[180:183], v13 offset:21760
    ds_read_b128 v[184:187], v13 offset:26112
    ds_read_b128 v[188:191], v13 offset:30464
    ds_read_b128 v[192:195], v13 offset:34816
    ds_read_b128 v[196:199], v13 offset:39168
    ds_read_b128 v[200:203], v13 offset:43520
    s_waitcnt lgkmcnt(10)
    s_mov_b32 s22, 0x0
    buffer_store_dwordx4 v[160:163], v10, s[8:11], s22 offen
    s_waitcnt lgkmcnt(9)
    s_mov_b32 s22, 0x10000
    buffer_store_dwordx4 v[164:167], v10, s[8:11], s22 offen
    s_waitcnt lgkmcnt(8)
    s_mov_b32 s22, 0x20000
    buffer_store_dwordx4 v[168:171], v10, s[8:11], s22 offen
    s_waitcnt lgkmcnt(7)
    s_mov_b32 s22, 0x30000
    buffer_store_dwordx4 v[172:175], v10, s[8:11], s22 offen
    s_waitcnt lgkmcnt(6)
    s_mov_b32 s22, 0x40000
    buffer_store_dwordx4 v[176:179], v10, s[8:11], s22 offen
    s_waitcnt lgkmcnt(5)
    s_mov_b32 s22, 0x50000
    buffer_store_dwordx4 v[180:183], v10, s[8:11], s22 offen
    s_waitcnt lgkmcnt(4)
    s_mov_b32 s22, 0x60000
    buffer_store_dwordx4 v[184:187], v10, s[8:11], s22 offen
    s_waitcnt lgkmcnt(3)
    s_mov_b32 s22, 0x70000
    buffer_store_dwordx4 v[188:191], v10, s[8:11], s22 offen
    s_waitcnt lgkmcnt(2)
    s_mov_b32 s22, 0x80000
    buffer_store_dwordx4 v[192:195], v10, s[8:11], s22 offen
    s_waitcnt lgkmcnt(1)
    s_mov_b32 s22, 0x90000
    buffer_store_dwordx4 v[196:199], v10, s[8:11], s22 offen
    s_waitcnt lgkmcnt(0)
    s_mov_b32 s22, 0xa0000
    buffer_store_dwordx4 v[200:203], v10, s[8:11], s22 offen
    s_waitcnt vmcnt(0)
    s_endpgm
g1_c_9:
    v_lshrrev_b32 v8, 2, v5
    v_lshl_add_u32 v8, v6, 3, v8
    v_mul_u32_u24 v8, 64, v8
    v_and_b32 v9, 3, v2
    v_lshl_add_u32 v8, v9, 3, v8
    v_add_u32 v19, 34816, v8
    s_barrier
    ds_read_b128 v[112:115], v20
    ds_read_b128 v[116:119], v20 offset:2048
    ds_read_b128 v[128:131], v22 offset:0
    ds_read_b128 v[132:135], v22 offset:2048
    ds_read_b128 v[136:139], v22 offset:4096
    ds_read_b128 v[140:143], v22 offset:6144
    ds_read_b128 v[144:147], v22 offset:8192
    ds_read_b128 v[148:151], v22 offset:10240
    s_cmp_eq_u32 s18, 1
    s_cbranch_scc1 g1_loop_9_1
    s_cmp_eq_u32 s18, 2
    s_cbranch_scc1 g1_loop_9_2
    s_cmp_eq_u32 s18, 3
    s_cbranch_scc1 g1_loop_9_3
g1_loop_9_0:
    ds_read_b128 v[152:155], v22 offset:12288
    s_waitcnt lgkmcnt(6)
    v_mfma_f32_16x16x32_bf16 v[24:27], v[112:115], v[128:131], v[24:27]
    v_mfma_f32_16x16x32_bf16 v[28:31], v[116:119], v[128:131], v[28:31]
    v_dot2c_f32_bf16 v212, s33, v128
    v_dot2c_f32_bf16 v212, s33, v129
    v_dot2c_f32_bf16 v212, s33, v130
    v_dot2c_f32_bf16 v212, s33, v131
    v_dot2c_f32_bf16 v216, s33, v112
    v_dot2c_f32_bf16 v217, v112, v112
    ds_read_b128 v[156:159], v22 offset:14336
    s_waitcnt lgkmcnt(6)
    v_mfma_f32_16x16x32_bf16 v[32:35], v[112:115], v[132:135], v[32:35]
    v_mfma_f32_16x16x32_bf16 v[36:39], v[116:119], v[132:135], v[36:39]
    v_dot2c_f32_bf16 v216, s33, v113
    v_dot2c_f32_bf16 v217, v113, v113
    ds_read_b128 v[160:163], v22 offset:16384
    s_waitcnt lgkmcnt(6)
    v_mfma_f32_16x16x32_bf16 v[40:43], v[112:115], v[136:139], v[40:43]
    v_mfma_f32_16x16x32_bf16 v[44:47], v[116:119], v[136:139], v[44:47]
    v_dot2c_f32_bf16 v216, s33, v114
    v_dot2c_f32_bf16 v217, v114, v114
    ds_read_b64_tr_b16 v[164:165], v19 offset:0
    ds_read_b64_tr_b16 v[166:167], v19 offset:256
    s_waitcnt lgkmcnt(7)
    v_mfma_f32_16x16x32_bf16 v[48:51], v[112:115], v[140:143], v[48:51]
    v_mfma_f32_16x16x32_bf16 v[52:55], v[116:119], v[140:143], v[52:55]
    v_dot2c_f32_bf16 v216, s33, v115
    v_dot2c_f32_bf16 v217, v115, v115
    ds_read_b64_tr_b16 v[168:169], v19 offset:32
    ds_read_b64_tr_b16 v[170:171], v19 offset:288
    s_waitcnt lgkmcnt(8)
    v_mfma_f32_16x16x32_bf16 v[56:59], v[112:115], v[144:147], v[56:59]
    v_mfma_f32_16x16x32_bf16 v[60:63], v[116:119], v[144:147], v[60:63]
    v_dot2c_f32_bf16 v213, s33, v144
    v_dot2c_f32_bf16 v213, s33, v145
    v_dot2c_f32_bf16 v213, s33, v146
    v_dot2c_f32_bf16 v213, s33, v147
    v_dot2c_f32_bf16 v218, s33, v116
    v_dot2c_f32_bf16 v219, v116, v116
    ds_read_b128 v[120:123], v21
    ds_read_b128 v[124:127], v21 offset:2048
    ds_read_b128 v[128:131], v23 offset:0
    s_waitcnt lgkmcnt(10)
    v_mfma_f32_16x16x32_bf16 v[64:67], v[112:115], v[148:151], v[64:67]
    v_mfma_f32_16x16x32_bf16 v[68:71], v[116:119], v[148:151], v[68:71]
    v_dot2c_f32_bf16 v218, s33, v117
    v_dot2c_f32_bf16 v219, v117, v117
    ds_read_b128 v[132:135], v23 offset:2048
    s_waitcnt lgkmcnt(10)
    v_mfma_f32_16x16x32_bf16 v[72:75], v[112:115], v[152:155], v[72:75]
    v_mfma_f32_16x16x32_bf16 v[76:79], v[116:119], v[152:155], v[76:79]
    v_dot2c_f32_bf16 v218, s33, v118
    v_dot2c_f32_bf16 v219, v118, v118
    ds_read_b128 v[136:139], v23 offset:4096
    s_waitcnt lgkmcnt(10)
    v_mfma_f32_16x16x32_bf16 v[80:83], v[112:115], v[156:159], v[80:83]
    v_mfma_f32_16x16x32_bf16 v[84:87], v[116:119], v[156:159], v[84:87]
    v_dot2c_f32_bf16 v218, s33, v119
    v_dot2c_f32_bf16 v219, v119, v119
    ds_read_b128 v[140:143], v23 offset:6144
    s_waitcnt lgkmcnt(10)
    v_mfma_f32_16x16x32_bf16 v[88:91], v[112:115], v[160:163], v[88:91]
    v_mfma_f32_16x16x32_bf16 v[92:95], v[116:119], v[160:163], v[92:95]
    v_dot2c_f32_bf16 v214, s33, v160
    v_dot2c_f32_bf16 v214, s33, v161
    v_dot2c_f32_bf16 v214, s33, v162
    v_dot2c_f32_bf16 v214, s33, v163
    ds_read_b128 v[144:147], v23 offset:8192
    s_waitcnt lgkmcnt(9)
    v_mfma_f32_16x16x32_bf16 v[96:99], v[164:167], v[112:115], v[96:99]
    v_mfma_f32_16x16x32_bf16 v[100:103], v[164:167], v[116:119], v[100:103]
    ds_read_b128 v[148:151], v23 offset:10240
    s_waitcnt lgkmcnt(8)
    v_mfma_f32_16x16x32_bf16 v[104:107], v[168:171], v[112:115], v[104:107]
    v_mfma_f32_16x16x32_bf16 v[108:111], v[168:171], v[116:119], v[108:111]
    ds_read_b128 v[152:155], v23 offset:12288
    s_waitcnt lgkmcnt(6)
    v_mfma_f32_16x16x32_bf16 v[24:27], v[120:123], v[128:131], v[24:27]
    v_mfma_f32_16x16x32_bf16 v[28:31], v[124:127], v[128:131], v[28:31]
    v_dot2c_f32_bf16 v212, s33, v128
    v_dot2c_f32_bf16 v212, s33, v129
    v_dot2c_f32_bf16 v212, s33, v130
    v_dot2c_f32_bf16 v212, s33, v131
    v_dot2c_f32_bf16 v216, s33, v120
    v_dot2c_f32_bf16 v217, v120, v120
    ds_read_b128 v[156:159], v23 offset:14336
    s_waitcnt lgkmcnt(6)
    v_mfma_f32_16x16x32_bf16 v[32:35], v[120:123], v[132:135], v[32:35]
    v_mfma_f32_16x16x32_bf16 v[36:39], v[124:127], v[132:135], v[36:39]
    v_dot2c_f32_bf16 v216, s33, v121
    v_dot2c_f32_bf16 v217, v121, v121
    ds_read_b128 v[160:163], v23 offset:16384
    s_waitcnt lgkmcnt(6)
    v_mfma_f32_16x16x32_bf16 v[40:43], v[120:123], v[136:139], v[40:43]
    v_mfma_f32_16x16x32_bf16 v[44:47], v[124:127], v[136:139], v[44:47]
    v_dot2c_f32_bf16 v216, s33, v122
    v_dot2c_f32_bf16 v217, v122, v122
    ds_read_b64_tr_b16 v[164:165], v19 offset:2048
    ds_read_b64_tr_b16 v[166:167], v19 offset:2304
    s_waitcnt lgkmcnt(7)
    v_mfma_f32_16x16x32_bf16 v[48:51], v[120:123], v[140:143], v[48:51]
    v_mfma_f32_16x16x32_bf16 v[52:55], v[124:127], v[140:143], v[52:55]
    v_dot2c_f32_bf16 v216, s33, v123
    v_dot2c_f32_bf16 v217, v123, v123
    ds_read_b64_tr_b16 v[168:169], v19 offset:2080
    ds_read_b64_tr_b16 v[170:171], v19 offset:2336
    s_waitcnt lgkmcnt(8)
    v_mfma_f32_16x16x32_bf16 v[56:59], v[120:123], v[144:147], v[56:59]
    v_mfma_f32_16x16x32_bf16 v[60:63], v[124:127], v[144:147], v[60:63]
    v_dot2c_f32_bf16 v213, s33, v144
    v_dot2c_f32_bf16 v213, s33, v145
    v_dot2c_f32_bf16 v213, s33, v146
    v_dot2c_f32_bf16 v213, s33, v147
    v_dot2c_f32_bf16 v218, s33, v124
    v_dot2c_f32_bf16 v219, v124, v124
    s_barrier
    s_add_u32 s28, s28, 38912
    s_cmp_ge_u32 s28, 155648
    s_cselect_b32 s34, 155648, 0
    s_cselect_b32 s28, 0, s28
    s_sub_u32 s34, 38912, s34
    v_add_u32 v20, s34, v20
    v_add_u32 v21, s34, v21
    v_add_u32 v22, s34, v22
    v_add_u32 v23, s34, v23
    v_add_u32 v19, s34, v19
    ds_read_b128 v[112:115], v20
    ds_read_b128 v[116:119], v20 offset:2048
    ds_read_b128 v[128:131], v22 offset:0
    s_waitcnt lgkmcnt(10)
    v_mfma_f32_16x16x32_bf16 v[64:67], v[120:123], v[148:151], v[64:67]
    v_mfma_f32_16x16x32_bf16 v[68:71], v[124:127], v[148:151], v[68:71]
    v_dot2c_f32_bf16 v218, s33, v125
    v_dot2c_f32_bf16 v219, v125, v125
    ds_read_b128 v[132:135], v22 offset:2048
    s_waitcnt lgkmcnt(10)
    v_mfma_f32_16x16x32_bf16 v[72:75], v[120:123], v[152:155], v[72:75]
    v_mfma_f32_16x16x32_bf16 v[76:79], v[124:127], v[152:155], v[76:79]
    v_dot2c_f32_bf16 v218, s33, v126
    v_dot2c_f32_bf16 v219, v126, v126
    ds_read_b128 v[136:139], v22 offset:4096
    s_waitcnt lgkmcnt(10)
    v_mfma_f32_16x16x32_bf16 v[80:83], v[120:123], v[156:159], v[80:83]
    v_mfma_f32_16x16x32_bf16 v[84:87], v[124:127], v[156:159], v[84:87]
    v_dot2c_f32_bf16 v218, s33, v127
    v_dot2c_f32_bf16 v219, v127, v127
    ds_read_b128 v[140:143], v22 offset:6144
    s_waitcnt lgkmcnt(10)
    v_mfma_f32_16x16x32_bf16 v[88:91], v[120:123], v[160:163], v[88:91]
    v_mfma_f32_16x16x32_bf16 v[92:95], v[124:127], v[160:163], v[92:95]
    v_dot2c_f32_bf16 v214, s33, v160
    v_dot2c_f32_bf16 v214, s33, v161
    v_dot2c_f32_bf16 v214, s33, v162
    v_dot2c_f32_bf16 v214, s33, v163
    ds_read_b128 v[144:147], v22 offset:8192
    s_waitcnt lgkmcnt(9)
    v_mfma_f32_16x16x32_bf16 v[96:99], v[164:167], v[120:123], v[96:99]
    v_mfma_f32_16x16x32_bf16 v[100:103], v[164:167], v[124:127], v[100:103]
    ds_read_b128 v[148:151], v22 offset:10240
    s_waitcnt lgkmcnt(8)
    v_mfma_f32_16x16x32_bf16 v[104:107], v[168:171], v[120:123], v[104:107]
    v_mfma_f32_16x16x32_bf16 v[108:111], v[168:171], v[124:127], v[108:111]
    s_add_u32 s32, s32, 1
    s_cmp_lt_u32 s32, 8
    s_cbranch_scc1 g1_loop_9_0
    s_branch g1_post_9
g1_loop_9_1:
    ds_read_b128 v[152:155], v22 offset:12288
    s_waitcnt lgkmcnt(6)
    v_mfma_f32_16x16x32_bf16 v[24:27], v[112:115], v[128:131], v[24:27]
    v_mfma_f32_16x16x32_bf16 v[28:31], v[116:119], v[128:131], v[28:31]
    v_dot2c_f32_bf16 v216, s33, v112
    v_dot2c_f32_bf16 v217, v112, v112
    ds_read_b128 v[156:159], v22 offset:14336
    s_waitcnt lgkmcnt(6)
    v_mfma_f32_16x16x32_bf16 v[32:35], v[112:115], v[132:135], v[32:35]
    v_mfma_f32_16x16x32_bf16 v[36:39], v[116:119], v[132:135], v[36:39]
    v_dot2c_f32_bf16 v212, s33, v132
    v_dot2c_f32_bf16 v212, s33, v133
    v_dot2c_f32_bf16 v212, s33, v134
    v_dot2c_f32_bf16 v212, s33, v135
    v_dot2c_f32_bf16 v216, s33, v113
    v_dot2c_f32_bf16 v217, v113, v113
    ds_read_b128 v[160:163], v22 offset:16384
    s_waitcnt lgkmcnt(6)
    v_mfma_f32_16x16x32_bf16 v[40:43], v[112:115], v[136:139], v[40:43]
    v_mfma_f32_16x16x32_bf16 v[44:47], v[116:119], v[136:139], v[44:47]
    v_dot2c_f32_bf16 v216, s33, v114
    v_dot2c_f32_bf16 v217, v114, v114
    ds_read_b64_tr_b16 v[164:165], v19 offset:0
    ds_read_b64_tr_b16 v[166:167], v19 offset:256
    s_waitcnt lgkmcnt(7)
    v_mfma_f32_16x16x32_bf16 v[48:51], v[112:115], v[140:143], v[48:51]
    v_mfma_f32_16x16x32_bf16 v[52:55], v[116:119], v[140:143], v[52:55]
    v_dot2c_f32_bf16 v216, s33, v115
    v_dot2c_f32_bf16 v217, v115, v115
    ds_read_b64_tr_b16 v[168:169], v19 offset:32
    ds_read_b64_tr_b16 v[170:171], v19 offset:288
    s_waitcnt lgkmcnt(8)
    v_mfma_f32_16x16x32_bf16 v[56:59], v[112:115], v[144:147], v[56:59]
    v_mfma_f32_16x16x32_bf16 v[60:63], v[116:119], v[144:147], v[60:63]
    v_dot2c_f32_bf16 v218, s33, v116
    v_dot2c_f32_bf16 v219, v116, v116
    ds_read_b128 v[120:123], v21
    ds_read_b128 v[124:127], v21 offset:2048
    ds_read_b128 v[128:131], v23 offset:0
    s_waitcnt lgkmcnt(10)
    v_mfma_f32_16x16x32_bf16 v[64:67], v[112:115], v[148:151], v[64:67]
    v_mfma_f32_16x16x32_bf16 v[68:71], v[116:119], v[148:151], v[68:71]
    v_dot2c_f32_bf16 v213, s33, v148
    v_dot2c_f32_bf16 v213, s33, v149
    v_dot2c_f32_bf16 v213, s33, v150
    v_dot2c_f32_bf16 v213, s33, v151
    v_dot2c_f32_bf16 v218, s33, v117
    v_dot2c_f32_bf16 v219, v117, v117
    ds_read_b128 v[132:135], v23 offset:2048
    s_waitcnt lgkmcnt(10)
    v_mfma_f32_16x16x32_bf16 v[72:75], v[112:115], v[152:155], v[72:75]
    v_mfma_f32_16x16x32_bf16 v[76:79], v[116:119], v[152:155], v[76:79]
    v_dot2c_f32_bf16 v218, s33, v118
    v_dot2c_f32_bf16 v219, v118, v118
    ds_read_b128 v[136:139], v23 offset:4096
    s_waitcnt lgkmcnt(10)
    v_mfma_f32_16x16x32_bf16 v[80:83], v[112:115], v[156:159], v[80:83]
    v_mfma_f32_16x16x32_bf16 v[84:87], v[116:119], v[156:159], v[84:87]
    v_dot2c_f32_bf16 v218, s33, v119
    v_dot2c_f32_bf16 v219, v119, v119
    ds_read_b128 v[140:143], v23 offset:6144
    s_waitcnt lgkmcnt(10)
    v_mfma_f32_16x16x32_bf16 v[88:91], v[112:115], v[160:163], v[88:91]
    v_mfma_f32_16x16x32_bf16 v[92:95], v[116:119], v[160:163], v[92:95]
    ds_read_b128 v[144:147], v23 offset:8192
    s_waitcnt lgkmcnt(9)
    v_mfma_f32_16x16x32_bf16 v[96:99], v[164:167], v[112:115], v[96:99]
    v_mfma_f32_16x16x32_bf16 v[100:103], v[164:167], v[116:119], v[100:103]
    v_dot2c_f32_bf16 v214, s33, v164
    v_dot2c_f32_bf16 v214, s33, v165
    v_dot2c_f32_bf16 v214, s33, v166
    v_dot2c_f32_bf16 v214, s33, v167
    ds_read_b128 v[148:151], v23 offset:10240
    s_waitcnt lgkmcnt(8)
    v_mfma_f32_16x16x32_bf16 v[104:107], v[168:171], v[112:115], v[104:107]
    v_mfma_f32_16x16x32_bf16 v[108:111], v[168:171], v[116:119], v[108:111]
    ds_read_b128 v[152:155], v23 offset:12288
    s_waitcnt lgkmcnt(6)
    v_mfma_f32_16x16x32_bf16 v[24:27], v[120:123], v[128:131], v[24:27]
    v_mfma_f32_16x16x32_bf16 v[28:31], v[124:127], v[128:131], v[28:31]
    v_dot2c_f32_bf16 v216, s33, v120
    v_dot2c_f32_bf16 v217, v120, v120
    ds_read_b128 v[156:159], v23 offset:14336
    s_waitcnt lgkmcnt(6)
    v_mfma_f32_16x16x32_bf16 v[32:35], v[120:123], v[132:135], v[32:35]
    v_mfma_f32_16x16x32_bf16 v[36:39], v[124:127], v[132:135], v[36:39]
    v_dot2c_f32_bf16 v212, s33, v132
    v_dot2c_f32_bf16 v212, s33, v133
    v_dot2c_f32_bf16 v212, s33, v134
    v_dot2c_f32_bf16 v212, s33, v135
    v_dot2c_f32_bf16 v216, s33, v121
    v_dot2c_f32_bf16 v217, v121, v121
    ds_read_b128 v[160:163], v23 offset:16384
    s_waitcnt lgkmcnt(6)
    v_mfma_f32_16x16x32_bf16 v[40:43], v[120:123], v[136:139], v[40:43]
    v_mfma_f32_16x16x32_bf16 v[44:47], v[124:127], v[136:139], v[44:47]
    v_dot2c_f32_bf16 v216, s33, v122
    v_dot2c_f32_bf16 v217, v122, v122
    ds_read_b64_tr_b16 v[164:165], v19 offset:2048
    ds_read_b64_tr_b16 v[166:167], v19 offset:2304
    s_waitcnt lgkmcnt(7)
    v_mfma_f32_16x16x32_bf16 v[48:51], v[120:123], v[140:143], v[48:51]
    v_mfma_f32_16x16x32_bf16 v[52:55], v[124:127], v[140:143], v[52:55]
    v_dot2c_f32_bf16 v216, s33, v123
    v_dot2c_f32_bf16 v217, v123, v123
    ds_read_b64_tr_b16 v[168:169], v19 offset:2080
    ds_read_b64_tr_b16 v[170:171], v19 offset:2336
    s_waitcnt lgkmcnt(8)
    v_mfma_f32_16x16x32_bf16 v[56:59], v[120:123], v[144:147], v[56:59]
    v_mfma_f32_16x16x32_bf16 v[60:63], v[124:127], v[144:147], v[60:63]
    v_dot2c_f32_bf16 v218, s33, v124
    v_dot2c_f32_bf16 v219, v124, v124
    s_barrier
    s_add_u32 s28, s28, 38912
    s_cmp_ge_u32 s28, 155648
    s_cselect_b32 s34, 155648, 0
    s_cselect_b32 s28, 0, s28
    s_sub_u32 s34, 38912, s34
    v_add_u32 v20, s34, v20
    v_add_u32 v21, s34, v21
    v_add_u32 v22, s34, v22
    v_add_u32 v23, s34, v23
    v_add_u32 v19, s34, v19
    ds_read_b128 v[112:115], v20
    ds_read_b128 v[116:119], v20 offset:2048
    ds_read_b128 v[128:131], v22 offset:0
    s_waitcnt lgkmcnt(10)
    v_mfma_f32_16x16x32_bf16 v[64:67], v[120:123], v[148:151], v[64:67]
    v_mfma_f32_16x16x32_bf16 v[68:71], v[124:127], v[148:151], v[68:71]
    v_dot2c_f32_bf16 v213, s33, v148
    v_dot2c_f32_bf16 v213, s33, v149
    v_dot2c_f32_bf16 v213, s33, v150
    v_dot2c_f32_bf16 v213, s33, v151
    v_dot2c_f32_bf16 v218, s33, v125
    v_dot2c_f32_bf16 v219, v125, v125
    ds_read_b128 v[132:135], v22 offset:2048
    s_waitcnt lgkmcnt(10)
    v_mfma_f32_16x16x32_bf16 v[72:75], v[120:123], v[152:155], v[72:75]
    v_mfma_f32_16x16x32_bf16 v[76:79], v[124:127], v[152:155], v[76:79]
    v_dot2c_f32_bf16 v218, s33, v126
    v_dot2c_f32_bf16 v219, v126, v126
    ds_read_b128 v[136:139], v22 offset:4096
    s_waitcnt lgkmcnt(10)
    v_mfma_f32_16x16x32_bf16 v[80:83], v[120:123], v[156:159], v[80:83]
    v_mfma_f32_16x16x32_bf16 v[84:87], v[124:127], v[156:159], v[84:87]
    v_dot2c_f32_bf16 v218, s33, v127
    v_dot2c_f32_bf16 v219, v127, v127
    ds_read_b128 v[140:143], v22 offset:6144
    s_waitcnt lgkmcnt(10)
    v_mfma_f32_16x16x32_bf16 v[88:91], v[120:123], v[160:163], v[88:91]
    v_mfma_f32_16x16x32_bf16 v[92:95], v[124:127], v[160:163], v[92:95]
    ds_read_b128 v[144:147], v22 offset:8192
    s_waitcnt lgkmcnt(9)
    v_mfma_f32_16x16x32_bf16 v[96:99], v[164:167], v[120:123], v[96:99]
    v_mfma_f32_16x16x32_bf16 v[100:103], v[164:167], v[124:127], v[100:103]
    v_dot2c_f32_bf16 v214, s33, v164
    v_dot2c_f32_bf16 v214, s33, v165
    v_dot2c_f32_bf16 v214, s33, v166
    v_dot2c_f32_bf16 v214, s33, v167
    ds_read_b128 v[148:151], v22 offset:10240
    s_waitcnt lgkmcnt(8)
    v_mfma_f32_16x16x32_bf16 v[104:107], v[168:171], v[120:123], v[104:107]
    v_mfma_f32_16x16x32_bf16 v[108:111], v[168:171], v[124:127], v[108:111]
    s_add_u32 s32, s32, 1
    s_cmp_lt_u32 s32, 8
    s_cbranch_scc1 g1_loop_9_1
    s_branch g1_post_9
g1_loop_9_2:
    ds_read_b128 v[152:155], v22 offset:12288
    s_waitcnt lgkmcnt(6)
    v_mfma_f32_16x16x32_bf16 v[24:27], v[112:115], v[128:131], v[24:27]
    v_mfma_f32_16x16x32_bf16 v[28:31], v[116:119], v[128:131], v[28:31]
    v_dot2c_f32_bf16 v216, s33, v112
    v_dot2c_f32_bf16 v217, v112, v112
    ds_read_b128 v[156:159], v22 offset:14336
    s_waitcnt lgkmcnt(6)
    v_mfma_f32_16x16x32_bf16 v[32:35], v[112:115], v[132:135], v[32:35]
    v_mfma_f32_16x16x32_bf16 v[36:39], v[116:119], v[132:135], v[36:39]
    v_dot2c_f32_bf16 v216, s33, v113
    v_dot2c_f32_bf16 v217, v113, v113
    ds_read_b128 v[160:163], v22 offset:16384
    s_waitcnt lgkmcnt(6)
    v_mfma_f32_16x16x32_bf16 v[40:43], v[112:115], v[136:139], v[40:43]
    v_mfma_f32_16x16x32_bf16 v[44:47], v[116:119], v[136:139], v[44:47]
    v_dot2c_f32_bf16 v212, s33, v136
    v_dot2c_f32_bf16 v212, s33, v137
    v_dot2c_f32_bf16 v212, s33, v138
    v_dot2c_f32_bf16 v212, s33, v139
    v_dot2c_f32_bf16 v216, s33, v114
    v_dot2c_f32_bf16 v217, v114, v114
    ds_read_b64_tr_b16 v[164:165], v19 offset:0
    ds_read_b64_tr_b16 v[166:167], v19 offset:256
    s_waitcnt lgkmcnt(7)
    v_mfma_f32_16x16x32_bf16 v[48:51], v[112:115], v[140:143], v[48:51]
    v_mfma_f32_16x16x32_bf16 v[52:55], v[116:119], v[140:143], v[52:55]
    v_dot2c_f32_bf16 v216, s33, v115
    v_dot2c_f32_bf16 v217, v115, v115
    ds_read_b64_tr_b16 v[168:169], v19 offset:32
    ds_read_b64_tr_b16 v[170:171], v19 offset:288
    s_waitcnt lgkmcnt(8)
    v_mfma_f32_16x16x32_bf16 v[56:59], v[112:115], v[144:147], v[56:59]
    v_mfma_f32_16x16x32_bf16 v[60:63], v[116:119], v[144:147], v[60:63]
    v_dot2c_f32_bf16 v218, s33, v116
    v_dot2c_f32_bf16 v219, v116, v116
    ds_read_b128 v[120:123], v21
    ds_read_b128 v[124:127], v21 offset:2048
    ds_read_b128 v[128:131], v23 offset:0
    s_waitcnt lgkmcnt(10)
    v_mfma_f32_16x16x32_bf16 v[64:67], v[112:115], v[148:151], v[64:67]
    v_mfma_f32_16x16x32_bf16 v[68:71], v[116:119], v[148:151], v[68:71]
    v_dot2c_f32_bf16 v218, s33, v117
    v_dot2c_f32_bf16 v219, v117, v117
    ds_read_b128 v[132:135], v23 offset:2048
    s_waitcnt lgkmcnt(10)
    v_mfma_f32_16x16x32_bf16 v[72:75], v[112:115], v[152:155], v[72:75]
    v_mfma_f32_16x16x32_bf16 v[76:79], v[116:119], v[152:155], v[76:79]
    v_dot2c_f32_bf16 v213, s33, v152
    v_dot2c_f32_bf16 v213, s33, v153
    v_dot2c_f32_bf16 v213, s33, v154
    v_dot2c_f32_bf16 v213, s33, v155
    v_dot2c_f32_bf16 v218, s33, v118
    v_dot2c_f32_bf16 v219, v118, v118
    ds_read_b128 v[136:139], v23 offset:4096
    s_waitcnt lgkmcnt(10)
    v_mfma_f32_16x16x32_bf16 v[80:83], v[112:115], v[156:159], v[80:83]
    v_mfma_f32_16x16x32_bf16 v[84:87], v[116:119], v[156:159], v[84:87]
    v_dot2c_f32_bf16 v218, s33, v119
    v_dot2c_f32_bf16 v219, v119, v119
    ds_read_b128 v[140:143], v23 offset:6144
    s_waitcnt lgkmcnt(10)
    v_mfma_f32_16x16x32_bf16 v[88:91], v[112:115], v[160:163], v[88:91]
    v_mfma_f32_16x16x32_bf16 v[92:95], v[116:119], v[160:163], v[92:95]
    ds_read_b128 v[144:147], v23 offset:8192
    s_waitcnt lgkmcnt(9)
    v_mfma_f32_16x16x32_bf16 v[96:99], v[164:167], v[112:115], v[96:99]
    v_mfma_f32_16x16x32_bf16 v[100:103], v[164:167], v[116:119], v[100:103]
    ds_read_b128 v[148:151], v23 offset:10240
    s_waitcnt lgkmcnt(8)
    v_mfma_f32_16x16x32_bf16 v[104:107], v[168:171], v[112:115], v[104:107]
    v_mfma_f32_16x16x32_bf16 v[108:111], v[168:171], v[116:119], v[108:111]
    v_dot2c_f32_bf16 v214, s33, v168
    v_dot2c_f32_bf16 v214, s33, v169
    v_dot2c_f32_bf16 v214, s33, v170
    v_dot2c_f32_bf16 v214, s33, v171
    ds_read_b128 v[152:155], v23 offset:12288
    s_waitcnt lgkmcnt(6)
    v_mfma_f32_16x16x32_bf16 v[24:27], v[120:123], v[128:131], v[24:27]
    v_mfma_f32_16x16x32_bf16 v[28:31], v[124:127], v[128:131], v[28:31]
    v_dot2c_f32_bf16 v216, s33, v120
    v_dot2c_f32_bf16 v217, v120, v120
    ds_read_b128 v[156:159], v23 offset:14336
    s_waitcnt lgkmcnt(6)
    v_mfma_f32_16x16x32_bf16 v[32:35], v[120:123], v[132:135], v[32:35]
    v_mfma_f32_16x16x32_bf16 v[36:39], v[124:127], v[132:135], v[36:39]
    v_dot2c_f32_bf16 v216, s33, v121
    v_dot2c_f32_bf16 v217, v121, v121
    ds_read_b128 v[160:163], v23 offset:16384
    s_waitcnt lgkmcnt(6)
    v_mfma_f32_16x16x32_bf16 v[40:43], v[120:123], v[136:139], v[40:43]
    v_mfma_f32_16x16x32_bf16 v[44:47], v[124:127], v[136:139], v[44:47]
    v_dot2c_f32_bf16 v212, s33, v136
    v_dot2c_f32_bf16 v212, s33, v137
    v_dot2c_f32_bf16 v212, s33, v138
    v_dot2c_f32_bf16 v212, s33, v139
    v_dot2c_f32_bf16 v216, s33, v122
    v_dot2c_f32_bf16 v217, v122, v122
    ds_read_b64_tr_b16 v[164:165], v19 offset:2048
    ds_read_b64_tr_b16 v[166:167], v19 offset:2304
    s_waitcnt lgkmcnt(7)
    v_mfma_f32_16x16x32_bf16 v[48:51], v[120:123], v[140:143], v[48:51]
    v_mfma_f32_16x16x32_bf16 v[52:55], v[124:127], v[140:143], v[52:55]
    v_dot2c_f32_bf16 v216, s33, v123
    v_dot2c_f32_bf16 v217, v123, v123
    ds_read_b64_tr_b16 v[168:169], v19 offset:2080
    ds_read_b64_tr_b16 v[170:171], v19 offset:2336
    s_waitcnt lgkmcnt(8)
    v_mfma_f32_16x16x32_bf16 v[56:59], v[120:123], v[144:147], v[56:59]
    v_mfma_f32_16x16x32_bf16 v[60:63], v[124:127], v[144:147], v[60:63]
    v_dot2c_f32_bf16 v218, s33, v124
    v_dot2c_f32_bf16 v219, v124, v124
    s_barrier
    s_add_u32 s28, s28, 38912
    s_cmp_ge_u32 s28, 155648
    s_cselect_b32 s34, 155648, 0
    s_cselect_b32 s28, 0, s28
    s_sub_u32 s34, 38912, s34
    v_add_u32 v20, s34, v20
    v_add_u32 v21, s34, v21
    v_add_u32 v22, s34, v22
    v_add_u32 v23, s34, v23
    v_add_u32 v19, s34, v19
    ds_read_b128 v[112:115], v20
    ds_read_b128 v[116:119], v20 offset:2048
    ds_read_b128 v[128:131], v22 offset:0
    s_waitcnt lgkmcnt(10)
    v_mfma_f32_16x16x32_bf16 v[64:67], v[120:123], v[148:151], v[64:67]
    v_mfma_f32_16x16x32_bf16 v[68:71], v[124:127], v[148:151], v[68:71]
    v_dot2c_f32_bf16 v218, s33, v125
    v_dot2c_f32_bf16 v219, v125, v125
    ds_read_b128 v[132:135], v22 offset:2048
    s_waitcnt lgkmcnt(10)
    v_mfma_f32_16x16x32_bf16 v[72:75], v[120:123], v[152:155], v[72:75]
    v_mfma_f32_16x16x32_bf16 v[76:79], v[124:127], v[152:155], v[76:79]
    v_dot2c_f32_bf16 v213, s33, v152
    v_dot2c_f32_bf16 v213, s33, v153
    v_dot2c_f32_bf16 v213, s33, v154
    v_dot2c_f32_bf16 v213, s33, v155
    v_dot2c_f32_bf16 v218, s33, v126
    v_dot2c_f32_bf16 v219, v126, v126
    ds_read_b128 v[136:139], v22 offset:4096
    s_waitcnt lgkmcnt(10)
    v_mfma_f32_16x16x32_bf16 v[80:83], v[120:123], v[156:159], v[80:83]
    v_mfma_f32_16x16x32_bf16 v[84:87], v[124:127], v[156:159], v[84:87]
    v_dot2c_f32_bf16 v218, s33, v127
    v_dot2c_f32_bf16 v219, v127, v127
    ds_read_b128 v[140:143], v22 offset:6144
    s_waitcnt lgkmcnt(10)
    v_mfma_f32_16x16x32_bf16 v[88:91], v[120:123], v[160:163], v[88:91]
    v_mfma_f32_16x16x32_bf16 v[92:95], v[124:127], v[160:163], v[92:95]
    ds_read_b128 v[144:147], v22 offset:8192
    s_waitcnt lgkmcnt(9)
    v_mfma_f32_16x16x32_bf16 v[96:99], v[164:167], v[120:123], v[96:99]
    v_mfma_f32_16x16x32_bf16 v[100:103], v[164:167], v[124:127], v[100:103]
    ds_read_b128 v[148:151], v22 offset:10240
    s_waitcnt lgkmcnt(8)
    v_mfma_f32_16x16x32_bf16 v[104:107], v[168:171], v[120:123], v[104:107]
    v_mfma_f32_16x16x32_bf16 v[108:111], v[168:171], v[124:127], v[108:111]
    v_dot2c_f32_bf16 v214, s33, v168
    v_dot2c_f32_bf16 v214, s33, v169
    v_dot2c_f32_bf16 v214, s33, v170
    v_dot2c_f32_bf16 v214, s33, v171
    s_add_u32 s32, s32, 1
    s_cmp_lt_u32 s32, 8
    s_cbranch_scc1 g1_loop_9_2
    s_branch g1_post_9
g1_loop_9_3:
    ds_read_b128 v[152:155], v22 offset:12288
    s_waitcnt lgkmcnt(6)
    v_mfma_f32_16x16x32_bf16 v[24:27], v[112:115], v[128:131], v[24:27]
    v_mfma_f32_16x16x32_bf16 v[28:31], v[116:119], v[128:131], v[28:31]
    v_dot2c_f32_bf16 v216, s33, v112
    v_dot2c_f32_bf16 v217, v112, v112
    ds_read_b128 v[156:159], v22 offset:14336
    s_waitcnt lgkmcnt(6)
    v_mfma_f32_16x16x32_bf16 v[32:35], v[112:115], v[132:135], v[32:35]
    v_mfma_f32_16x16x32_bf16 v[36:39], v[116:119], v[132:135], v[36:39]
    v_dot2c_f32_bf16 v216, s33, v113
    v_dot2c_f32_bf16 v217, v113, v113
    ds_read_b128 v[160:163], v22 offset:16384
    s_waitcnt lgkmcnt(6)
    v_mfma_f32_16x16x32_bf16 v[40:43], v[112:115], v[136:139], v[40:43]
    v_mfma_f32_16x16x32_bf16 v[44:47], v[116:119], v[136:139], v[44:47]
    v_dot2c_f32_bf16 v216, s33, v114
    v_dot2c_f32_bf16 v217, v114, v114
    ds_read_b64_tr_b16 v[164:165], v19 offset:0
    ds_read_b64_tr_b16 v[166:167], v19 offset:256
    s_waitcnt lgkmcnt(7)
    v_mfma_f32_16x16x32_bf16 v[48:51], v[112:115], v[140:143], v[48:51]
    v_mfma_f32_16x16x32_bf16 v[52:55], v[116:119], v[140:143], v[52:55]
    v_dot2c_f32_bf16 v212, s33, v140
    v_dot2c_f32_bf16 v212, s33, v141
    v_dot2c_f32_bf16 v212, s33, v142
    v_dot2c_f32_bf16 v212, s33, v143
    v_dot2c_f32_bf16 v216, s33, v115
    v_dot2c_f32_bf16 v217, v115, v115
    ds_read_b64_tr_b16 v[168:169], v19 offset:32
    ds_read_b64_tr_b16 v[170:171], v19 offset:288
    s_waitcnt lgkmcnt(8)
    v_mfma_f32_16x16x32_bf16 v[56:59], v[112:115], v[144:147], v[56:59]
    v_mfma_f32_16x16x32_bf16 v[60:63], v[116:119], v[144:147], v[60:63]
    v_dot2c_f32_bf16 v218, s33, v116
    v_dot2c_f32_bf16 v219, v116, v116
    ds_read_b128 v[120:123], v21
    ds_read_b128 v[124:127], v21 offset:2048
    ds_read_b128 v[128:131], v23 offset:0
    s_waitcnt lgkmcnt(10)
    v_mfma_f32_16x16x32_bf16 v[64:67], v[112:115], v[148:151], v[64:67]
    v_mfma_f32_16x16x32_bf16 v[68:71], v[116:119], v[148:151], v[68:71]
    v_dot2c_f32_bf16 v218, s33, v117
    v_dot2c_f32_bf16 v219, v117, v117
    ds_read_b128 v[132:135], v23 offset:2048
    s_waitcnt lgkmcnt(10)
    v_mfma_f32_16x16x32_bf16 v[72:75], v[112:115], v[152:155], v[72:75]
    v_mfma_f32_16x16x32_bf16 v[76:79], v[116:119], v[152:155], v[76:79]
    v_dot2c_f32_bf16 v218, s33, v118
    v_dot2c_f32_bf16 v219, v118, v118
    ds_read_b128 v[136:139], v23 offset:4096
    s_waitcnt lgkmcnt(10)
    v_mfma_f32_16x16x32_bf16 v[80:83], v[112:115], v[156:159], v[80:83]
    v_mfma_f32_16x16x32_bf16 v[84:87], v[116:119], v[156:159], v[84:87]
    v_dot2c_f32_bf16 v213, s33, v156
    v_dot2c_f32_bf16 v213, s33, v157
    v_dot2c_f32_bf16 v213, s33, v158
    v_dot2c_f32_bf16 v213, s33, v159
    v_dot2c_f32_bf16 v218, s33, v119
    v_dot2c_f32_bf16 v219, v119, v119
    ds_read_b128 v[140:143], v23 offset:6144
    s_waitcnt lgkmcnt(10)
    v_mfma_f32_16x16x32_bf16 v[88:91], v[112:115], v[160:163], v[88:91]
    v_mfma_f32_16x16x32_bf16 v[92:95], v[116:119], v[160:163], v[92:95]
    ds_read_b128 v[144:147], v23 offset:8192
    s_waitcnt lgkmcnt(9)
    v_mfma_f32_16x16x32_bf16 v[96:99], v[164:167], v[112:115], v[96:99]
    v_mfma_f32_16x16x32_bf16 v[100:103], v[164:167], v[116:119], v[100:103]
    ds_read_b128 v[148:151], v23 offset:10240
    s_waitcnt lgkmcnt(8)
    v_mfma_f32_16x16x32_bf16 v[104:107], v[168:171], v[112:115], v[104:107]
    v_mfma_f32_16x16x32_bf16 v[108:111], v[168:171], v[116:119], v[108:111]
    ds_read_b128 v[152:155], v23 offset:12288
    s_waitcnt lgkmcnt(6)
    v_mfma_f32_16x16x32_bf16 v[24:27], v[120:123], v[128:131], v[24:27]
    v_mfma_f32_16x16x32_bf16 v[28:31], v[124:127], v[128:131], v[28:31]
    v_dot2c_f32_bf16 v216, s33, v120
    v_dot2c_f32_bf16 v217, v120, v120
    ds_read_b128 v[156:159], v23 offset:14336
    s_waitcnt lgkmcnt(6)
    v_mfma_f32_16x16x32_bf16 v[32:35], v[120:123], v[132:135], v[32:35]
    v_mfma_f32_16x16x32_bf16 v[36:39], v[124:127], v[132:135], v[36:39]
    v_dot2c_f32_bf16 v216, s33, v121
    v_dot2c_f32_bf16 v217, v121, v121
    ds_read_b128 v[160:163], v23 offset:16384
    s_waitcnt lgkmcnt(6)
    v_mfma_f32_16x16x32_bf16 v[40:43], v[120:123], v[136:139], v[40:43]
    v_mfma_f32_16x16x32_bf16 v[44:47], v[124:127], v[136:139], v[44:47]
    v_dot2c_f32_bf16 v216, s33, v122
    v_dot2c_f32_bf16 v217, v122, v122
    ds_read_b64_tr_b16 v[164:165], v19 offset:2048
    ds_read_b64_tr_b16 v[166:167], v19 offset:2304
    s_waitcnt lgkmcnt(7)
    v_mfma_f32_16x16x32_bf16 v[48:51], v[120:123], v[140:143], v[48:51]
    v_mfma_f32_16x16x32_bf16 v[52:55], v[124:127], v[140:143], v[52:55]
    v_dot2c_f32_bf16 v212, s33, v140
    v_dot2c_f32_bf16 v212, s33, v141
    v_dot2c_f32_bf16 v212, s33, v142
    v_dot2c_f32_bf16 v212, s33, v143
    v_dot2c_f32_bf16 v216, s33, v123
    v_dot2c_f32_bf16 v217, v123, v123
    ds_read_b64_tr_b16 v[168:169], v19 offset:2080
    ds_read_b64_tr_b16 v[170:171], v19 offset:2336
    s_waitcnt lgkmcnt(8)
    v_mfma_f32_16x16x32_bf16 v[56:59], v[120:123], v[144:147], v[56:59]
    v_mfma_f32_16x16x32_bf16 v[60:63], v[124:127], v[144:147], v[60:63]
    v_dot2c_f32_bf16 v218, s33, v124
    v_dot2c_f32_bf16 v219, v124, v124
    s_barrier
    s_add_u32 s28, s28, 38912
    s_cmp_ge_u32 s28, 155648
    s_cselect_b32 s34, 155648, 0
    s_cselect_b32 s28, 0, s28
    s_sub_u32 s34, 38912, s34
    v_add_u32 v20, s34, v20
    v_add_u32 v21, s34, v21
    v_add_u32 v22, s34, v22
    v_add_u32 v23, s34, v23
    v_add_u32 v19, s34, v19
    ds_read_b128 v[112:115], v20
    ds_read_b128 v[116:119], v20 offset:2048
    ds_read_b128 v[128:131], v22 offset:0
    s_waitcnt lgkmcnt(10)
    v_mfma_f32_16x16x32_bf16 v[64:67], v[120:123], v[148:151], v[64:67]
    v_mfma_f32_16x16x32_bf16 v[68:71], v[124:127], v[148:151], v[68:71]
    v_dot2c_f32_bf16 v218, s33, v125
    v_dot2c_f32_bf16 v219, v125, v125
    ds_read_b128 v[132:135], v22 offset:2048
    s_waitcnt lgkmcnt(10)
    v_mfma_f32_16x16x32_bf16 v[72:75], v[120:123], v[152:155], v[72:75]
    v_mfma_f32_16x16x32_bf16 v[76:79], v[124:127], v[152:155], v[76:79]
    v_dot2c_f32_bf16 v218, s33, v126
    v_dot2c_f32_bf16 v219, v126, v126
    ds_read_b128 v[136:139], v22 offset:4096
    s_waitcnt lgkmcnt(10)
    v_mfma_f32_16x16x32_bf16 v[80:83], v[120:123], v[156:159], v[80:83]
    v_mfma_f32_16x16x32_bf16 v[84:87], v[124:127], v[156:159], v[84:87]
    v_dot2c_f32_bf16 v213, s33, v156
    v_dot2c_f32_bf16 v213, s33, v157
    v_dot2c_f32_bf16 v213, s33, v158
    v_dot2c_f32_bf16 v213, s33, v159
    v_dot2c_f32_bf16 v218, s33, v127
    v_dot2c_f32_bf16 v219, v127, v127
    ds_read_b128 v[140:143], v22 offset:6144
    s_waitcnt lgkmcnt(10)
    v_mfma_f32_16x16x32_bf16 v[88:91], v[120:123], v[160:163], v[88:91]
    v_mfma_f32_16x16x32_bf16 v[92:95], v[124:127], v[160:163], v[92:95]
    ds_read_b128 v[144:147], v22 offset:8192
    s_waitcnt lgkmcnt(9)
    v_mfma_f32_16x16x32_bf16 v[96:99], v[164:167], v[120:123], v[96:99]
    v_mfma_f32_16x16x32_bf16 v[100:103], v[164:167], v[124:127], v[100:103]
    ds_read_b128 v[148:151], v22 offset:10240
    s_waitcnt lgkmcnt(8)
    v_mfma_f32_16x16x32_bf16 v[104:107], v[168:171], v[120:123], v[104:107]
    v_mfma_f32_16x16x32_bf16 v[108:111], v[168:171], v[124:127], v[108:111]
    s_add_u32 s32, s32, 1
    s_cmp_lt_u32 s32, 8
    s_cbranch_scc1 g1_loop_9_3
g1_post_9:
    s_waitcnt lgkmcnt(0)
    s_nop 3
    v_xor_b32 v8, 16, v2
    v_lshlrev_b32 v8, 2, v8
    v_xor_b32 v9, 32, v2
    v_lshlrev_b32 v9, 2, v9
    ds_bpermute_b32 v220, v8, v216
    ds_bpermute_b32 v221, v8, v217
    ds_bpermute_b32 v222, v8, v218
    ds_bpermute_b32 v223, v8, v219
    s_waitcnt lgkmcnt(0)
    v_add_f32 v216, v216, v220
    v_add_f32 v217, v217, v221
    v_add_f32 v218, v218, v222
    v_add_f32 v219, v219, v223
    ds_bpermute_b32 v220, v9, v216
    ds_bpermute_b32 v221, v9, v217
    ds_bpermute_b32 v222, v9, v218
    ds_bpermute_b32 v223, v9, v219
    s_waitcnt lgkmcnt(0)
    v_add_f32 v216, v216, v220
    v_add_f32 v217, v217, v221
    v_add_f32 v218, v218, v222
    v_add_f32 v219, v219, v223
    v_mul_f32 v216, 0x3b000000, v216
    v_mul_f32 v217, 0x3b000000, v217
    v_fma_f32 v217, -v216, v216, v217
    v_max_f32 v217, 0, v217
    v_cvt_pk_bf16_f32 v220, v216, v217
    v_lshlrev_b32 v216, 16, v220
    v_and_b32 v217, 0xffff0000, v220
    v_add_f32 v217, 0x3727c5ac, v217
    v_cvt_pk_bf16_f32 v220, v217, v217
    v_lshlrev_b32 v217, 16, v220
    v_sqrt_f32 v217, v217
    s_nop 1
    v_cvt_pk_bf16_f32 v220, v217, v217
    v_lshlrev_b32 v217, 16, v220
    v_rcp_f32 v217, v217
    s_nop 1
    v_mul_f32 v218, 0x3b000000, v218
    v_mul_f32 v219, 0x3b000000, v219
    v_fma_f32 v219, -v218, v218, v219
    v_max_f32 v219, 0, v219
    v_cvt_pk_bf16_f32 v220, v218, v219
    v_lshlrev_b32 v218, 16, v220
    v_and_b32 v219, 0xffff0000, v220
    v_add_f32 v219, 0x3727c5ac, v219
    v_cvt_pk_bf16_f32 v220, v219, v219
    v_lshlrev_b32 v219, 16, v220
    v_sqrt_f32 v219, v219
    s_nop 1
    v_cvt_pk_bf16_f32 v220, v219, v219
    v_lshlrev_b32 v219, 16, v220
    v_rcp_f32 v219, v219
    s_nop 1
    s_lshl_b32 s22, s18, 8
    s_add_u32 s22, s22, 155648
    v_lshlrev_b32 v8, 3, v5
    v_add_u32 v8, s22, v8
    ds_write_b64 v8, v[216:217]
    ds_write_b64 v8, v[218:219] offset:128
    s_nop 3
    s_lshl_b32 s34, s18, 6
    s_add_u32 s34, s34, 156672
    v_lshlrev_b32 v8, 2, v5
    v_add_u32 v8, s34, v8
    ds_add_f32 v8, v212
    ds_add_f32 v8, v213 offset:256
    s_cmp_eq_u32 s18, 3
    s_cbranch_scc1 g1_ws3_9
    ds_add_f32 v8, v214 offset:512
g1_ws3_9:
    s_waitcnt lgkmcnt(0)
    v_mov_b32 v8, 157440
    v_mov_b32 v9, 1
    s_mov_b64 s[34:35], exec
    s_mov_b64 exec, 1
    ds_add_u32 v8, v9
    s_mov_b64 exec, s[34:35]
    s_add_u32 s8, s6, 0x700000
    s_addc_u32 s9, s7, 0
    s_and_b32 s9, s9, 0xffff
    s_mov_b32 s10, 0x400000
    s_mov_b32 s11, 0x20000
    s_add_u32 s12, s6, 0xb00000
    s_addc_u32 s13, s7, 0
    s_and_b32 s13, s13, 0xffff
    s_mov_b32 s14, 0x800000
    s_mov_b32 s15, 0x20000
    s_mov_b32 s36, s4
    s_mov_b32 s37, s5
    s_and_b32 s37, s37, 0xffff
    s_mov_b32 s38, 0xe00
    s_mov_b32 s39, 0x20000
    s_lshl_b32 s20, s16, 7
    s_lshl_b32 s21, s18, 5
    s_add_u32 s20, s20, s21
    s_mul_i32 s21, s17, 176
    v_mul_u32_u24 v7, 272, v5
    v_lshl_add_u32 v7, v6, 3, v7
    s_lshl_b32 s22, s18, 6
    v_add_u32 v7, s22, v7
    s_lshl_b32 s22, s18, 8
    s_add_u32 s22, s22, 155648
    v_lshlrev_b32 v10, 5, v6
    v_add_u32 v10, s22, v10
    s_lshl_b32 s22, s18, 5
    v_add_u32 v11, s22, v5
    v_mul_u32_u24 v11, 368, v11
    v_lshl_add_u32 v11, v6, 3, v11
    v_add_u32 v11, 0x10000, v11
    s_sub_u32 s22, s21, 880
    s_lshl_b32 s22, s22, 1
    v_lshlrev_b32 v12, 3, v6
    v_add_u32 v12, s22, v12
    buffer_load_dwordx2 v[130:131], v12, s[36:39], 0 offen offset:0
    buffer_load_dwordx2 v[132:133], v12, s[36:39], 0 offen offset:32
    s_lshl_b32 s22, s18, 8
    s_add_u32 s22, s22, 155648
    v_lshlrev_b32 v13, 3, v5
    v_add_u32 v13, s22, v13
    v_mov_b32 v8, 157440
g1_poll_9:
    ds_read_b32 v9, v8
    s_waitcnt lgkmcnt(0)
    v_readfirstlane_b32 s22, v9
    s_nop 1
    s_cmp_lt_u32 s22, 4
    s_cbranch_scc1 g1_poll_9
    ds_read_b128 v[160:163], v10 offset:0
    ds_read_b128 v[164:167], v10 offset:16
    ds_read_b128 v[176:179], v10 offset:128
    ds_read_b128 v[180:183], v10 offset:144
    ds_read_b64 v[168:169], v13 offset:0
    ds_read_b64 v[184:185], v13 offset:128
    v_lshlrev_b32 v8, 2, v5
    v_add_u32 v8, 156672, v8
    ds_read_b32 v196, v8 offset:0
    ds_read_b32 v197, v8 offset:64
    ds_read_b32 v198, v8 offset:128
    ds_read_b32 v199, v8 offset:192
    ds_read_b32 v200, v8 offset:256
    ds_read_b32 v201, v8 offset:320
    ds_read_b32 v202, v8 offset:384
    ds_read_b32 v203, v8 offset:448
    ds_read_b32 v204, v8 offset:512
    v_lshlrev_b32 v9, 4, v6
    v_add_u32 v9, 156672, v9
    s_waitcnt lgkmcnt(0)
    s_add_u32 s22, s21, 0
    s_cmp_ge_u32 s22, 512
    s_cselect_b32 s23, 0x80008000, 0
    v_fma_f32 v24, -v160, v196, v24
    v_mul_f32 v24, v161, v24
    v_fma_f32 v25, -v162, v196, v25
    v_mul_f32 v25, v163, v25
    v_fma_f32 v26, -v164, v196, v26
    v_mul_f32 v26, v165, v26
    v_fma_f32 v27, -v166, v196, v27
    v_mul_f32 v27, v167, v27
    v_cvt_pk_bf16_f32 v24, v24, v25
    v_cvt_pk_bf16_f32 v25, v26, v27
    v_xor_b32 v24, s23, v24
    v_xor_b32 v25, s23, v25
    ds_write_b64 v7, v[24:25] offset:0
    v_fma_f32 v28, -v176, v196, v28
    v_mul_f32 v28, v177, v28
    v_fma_f32 v29, -v178, v196, v29
    v_mul_f32 v29, v179, v29
    v_fma_f32 v30, -v180, v196, v30
    v_mul_f32 v30, v181, v30
    v_fma_f32 v31, -v182, v196, v31
    v_mul_f32 v31, v183, v31
    v_cvt_pk_bf16_f32 v28, v28, v29
    v_cvt_pk_bf16_f32 v29, v30, v31
    v_xor_b32 v28, s23, v28
    v_xor_b32 v29, s23, v29
    ds_write_b64 v7, v[28:29] offset:32
    s_add_u32 s22, s21, 16
    s_cmp_ge_u32 s22, 512
    s_cselect_b32 s23, 0x80008000, 0
    v_fma_f32 v32, -v160, v197, v32
    v_mul_f32 v32, v161, v32
    v_fma_f32 v33, -v162, v197, v33
    v_mul_f32 v33, v163, v33
    v_fma_f32 v34, -v164, v197, v34
    v_mul_f32 v34, v165, v34
    v_fma_f32 v35, -v166, v197, v35
    v_mul_f32 v35, v167, v35
    v_cvt_pk_bf16_f32 v32, v32, v33
    v_cvt_pk_bf16_f32 v33, v34, v35
    v_xor_b32 v32, s23, v32
    v_xor_b32 v33, s23, v33
    ds_write_b64 v7, v[32:33] offset:4352
    v_fma_f32 v36, -v176, v197, v36
    v_mul_f32 v36, v177, v36
    v_fma_f32 v37, -v178, v197, v37
    v_mul_f32 v37, v179, v37
    v_fma_f32 v38, -v180, v197, v38
    v_mul_f32 v38, v181, v38
    v_fma_f32 v39, -v182, v197, v39
    v_mul_f32 v39, v183, v39
    v_cvt_pk_bf16_f32 v36, v36, v37
    v_cvt_pk_bf16_f32 v37, v38, v39
    v_xor_b32 v36, s23, v36
    v_xor_b32 v37, s23, v37
    ds_write_b64 v7, v[36:37] offset:4384
    s_add_u32 s22, s21, 32
    s_cmp_ge_u32 s22, 512
    s_cselect_b32 s23, 0x80008000, 0
    v_fma_f32 v40, -v160, v198, v40
    v_mul_f32 v40, v161, v40
    v_fma_f32 v41, -v162, v198, v41
    v_mul_f32 v41, v163, v41
    v_fma_f32 v42, -v164, v198, v42
    v_mul_f32 v42, v165, v42
    v_fma_f32 v43, -v166, v198, v43
    v_mul_f32 v43, v167, v43
    v_cvt_pk_bf16_f32 v40, v40, v41
    v_cvt_pk_bf16_f32 v41, v42, v43
    v_xor_b32 v40, s23, v40
    v_xor_b32 v41, s23, v41
    ds_write_b64 v7, v[40:41] offset:8704
    v_fma_f32 v44, -v176, v198, v44
    v_mul_f32 v44, v177, v44
    v_fma_f32 v45, -v178, v198, v45
    v_mul_f32 v45, v179, v45
    v_fma_f32 v46, -v180, v198, v46
    v_mul_f32 v46, v181, v46
    v_fma_f32 v47, -v182, v198, v47
    v_mul_f32 v47, v183, v47
    v_cvt_pk_bf16_f32 v44, v44, v45
    v_cvt_pk_bf16_f32 v45, v46, v47
    v_xor_b32 v44, s23, v44
    v_xor_b32 v45, s23, v45
    ds_write_b64 v7, v[44:45] offset:8736
    s_add_u32 s22, s21, 48
    s_cmp_ge_u32 s22, 512
    s_cselect_b32 s23, 0x80008000, 0
    v_fma_f32 v48, -v160, v199, v48
    v_mul_f32 v48, v161, v48
    v_fma_f32 v49, -v162, v199, v49
    v_mul_f32 v49, v163, v49
    v_fma_f32 v50, -v164, v199, v50
    v_mul_f32 v50, v165, v50
    v_fma_f32 v51, -v166, v199, v51
    v_mul_f32 v51, v167, v51
    v_cvt_pk_bf16_f32 v48, v48, v49
    v_cvt_pk_bf16_f32 v49, v50, v51
    v_xor_b32 v48, s23, v48
    v_xor_b32 v49, s23, v49
    ds_write_b64 v7, v[48:49] offset:13056
    v_fma_f32 v52, -v176, v199, v52
    v_mul_f32 v52, v177, v52
    v_fma_f32 v53, -v178, v199, v53
    v_mul_f32 v53, v179, v53
    v_fma_f32 v54, -v180, v199, v54
    v_mul_f32 v54, v181, v54
    v_fma_f32 v55, -v182, v199, v55
    v_mul_f32 v55, v183, v55
    v_cvt_pk_bf16_f32 v52, v52, v53
    v_cvt_pk_bf16_f32 v53, v54, v55
    v_xor_b32 v52, s23, v52
    v_xor_b32 v53, s23, v53
    ds_write_b64 v7, v[52:53] offset:13088
    s_add_u32 s22, s21, 64
    s_cmp_ge_u32 s22, 512
    s_cselect_b32 s23, 0x80008000, 0
    v_fma_f32 v56, -v160, v200, v56
    v_mul_f32 v56, v161, v56
    v_fma_f32 v57, -v162, v200, v57
    v_mul_f32 v57, v163, v57
    v_fma_f32 v58, -v164, v200, v58
    v_mul_f32 v58, v165, v58
    v_fma_f32 v59, -v166, v200, v59
    v_mul_f32 v59, v167, v59
    v_cvt_pk_bf16_f32 v56, v56, v57
    v_cvt_pk_bf16_f32 v57, v58, v59
    v_xor_b32 v56, s23, v56
    v_xor_b32 v57, s23, v57
    ds_write_b64 v7, v[56:57] offset:17408
    v_fma_f32 v60, -v176, v200, v60
    v_mul_f32 v60, v177, v60
    v_fma_f32 v61, -v178, v200, v61
    v_mul_f32 v61, v179, v61
    v_fma_f32 v62, -v180, v200, v62
    v_mul_f32 v62, v181, v62
    v_fma_f32 v63, -v182, v200, v63
    v_mul_f32 v63, v183, v63
    v_cvt_pk_bf16_f32 v60, v60, v61
    v_cvt_pk_bf16_f32 v61, v62, v63
    v_xor_b32 v60, s23, v60
    v_xor_b32 v61, s23, v61
    ds_write_b64 v7, v[60:61] offset:17440
    s_add_u32 s22, s21, 80
    s_cmp_ge_u32 s22, 512
    s_cselect_b32 s23, 0x80008000, 0
    v_fma_f32 v64, -v160, v201, v64
    v_mul_f32 v64, v161, v64
    v_fma_f32 v65, -v162, v201, v65
    v_mul_f32 v65, v163, v65
    v_fma_f32 v66, -v164, v201, v66
    v_mul_f32 v66, v165, v66
    v_fma_f32 v67, -v166, v201, v67
    v_mul_f32 v67, v167, v67
    v_cvt_pk_bf16_f32 v64, v64, v65
    v_cvt_pk_bf16_f32 v65, v66, v67
    v_xor_b32 v64, s23, v64
    v_xor_b32 v65, s23, v65
    ds_write_b64 v7, v[64:65] offset:21760
    v_fma_f32 v68, -v176, v201, v68
    v_mul_f32 v68, v177, v68
    v_fma_f32 v69, -v178, v201, v69
    v_mul_f32 v69, v179, v69
    v_fma_f32 v70, -v180, v201, v70
    v_mul_f32 v70, v181, v70
    v_fma_f32 v71, -v182, v201, v71
    v_mul_f32 v71, v183, v71
    v_cvt_pk_bf16_f32 v68, v68, v69
    v_cvt_pk_bf16_f32 v69, v70, v71
    v_xor_b32 v68, s23, v68
    v_xor_b32 v69, s23, v69
    ds_write_b64 v7, v[68:69] offset:21792
    s_add_u32 s22, s21, 96
    s_cmp_ge_u32 s22, 512
    s_cselect_b32 s23, 0x80008000, 0
    v_fma_f32 v72, -v160, v202, v72
    v_mul_f32 v72, v161, v72
    v_fma_f32 v73, -v162, v202, v73
    v_mul_f32 v73, v163, v73
    v_fma_f32 v74, -v164, v202, v74
    v_mul_f32 v74, v165, v74
    v_fma_f32 v75, -v166, v202, v75
    v_mul_f32 v75, v167, v75
    v_cvt_pk_bf16_f32 v72, v72, v73
    v_cvt_pk_bf16_f32 v73, v74, v75
    v_xor_b32 v72, s23, v72
    v_xor_b32 v73, s23, v73
    ds_write_b64 v7, v[72:73] offset:26112
    v_fma_f32 v76, -v176, v202, v76
    v_mul_f32 v76, v177, v76
    v_fma_f32 v77, -v178, v202, v77
    v_mul_f32 v77, v179, v77
    v_fma_f32 v78, -v180, v202, v78
    v_mul_f32 v78, v181, v78
    v_fma_f32 v79, -v182, v202, v79
    v_mul_f32 v79, v183, v79
    v_cvt_pk_bf16_f32 v76, v76, v77
    v_cvt_pk_bf16_f32 v77, v78, v79
    v_xor_b32 v76, s23, v76
    v_xor_b32 v77, s23, v77
    ds_write_b64 v7, v[76:77] offset:26144
    s_add_u32 s22, s21, 112
    s_cmp_ge_u32 s22, 512
    s_cselect_b32 s23, 0x80008000, 0
    v_fma_f32 v80, -v160, v203, v80
    v_mul_f32 v80, v161, v80
    v_fma_f32 v81, -v162, v203, v81
    v_mul_f32 v81, v163, v81
    v_fma_f32 v82, -v164, v203, v82
    v_mul_f32 v82, v165, v82
    v_fma_f32 v83, -v166, v203, v83
    v_mul_f32 v83, v167, v83
    v_cvt_pk_bf16_f32 v80, v80, v81
    v_cvt_pk_bf16_f32 v81, v82, v83
    v_xor_b32 v80, s23, v80
    v_xor_b32 v81, s23, v81
    ds_write_b64 v7, v[80:81] offset:30464
    v_fma_f32 v84, -v176, v203, v84
    v_mul_f32 v84, v177, v84
    v_fma_f32 v85, -v178, v203, v85
    v_mul_f32 v85, v179, v85
    v_fma_f32 v86, -v180, v203, v86
    v_mul_f32 v86, v181, v86
    v_fma_f32 v87, -v182, v203, v87
    v_mul_f32 v87, v183, v87
    v_cvt_pk_bf16_f32 v84, v84, v85
    v_cvt_pk_bf16_f32 v85, v86, v87
    v_xor_b32 v84, s23, v84
    v_xor_b32 v85, s23, v85
    ds_write_b64 v7, v[84:85] offset:30496
    s_add_u32 s22, s21, 128
    s_cmp_ge_u32 s22, 512
    s_cselect_b32 s23, 0x80008000, 0
    v_fma_f32 v88, -v160, v204, v88
    v_mul_f32 v88, v161, v88
    v_fma_f32 v89, -v162, v204, v89
    v_mul_f32 v89, v163, v89
    v_fma_f32 v90, -v164, v204, v90
    v_mul_f32 v90, v165, v90
    v_fma_f32 v91, -v166, v204, v91
    v_mul_f32 v91, v167, v91
    v_cvt_pk_bf16_f32 v88, v88, v89
    v_cvt_pk_bf16_f32 v89, v90, v91
    v_xor_b32 v88, s23, v88
    v_xor_b32 v89, s23, v89
    ds_write_b64 v7, v[88:89] offset:34816
    v_fma_f32 v92, -v176, v204, v92
    v_mul_f32 v92, v177, v92
    v_fma_f32 v93, -v178, v204, v93
    v_mul_f32 v93, v179, v93
    v_fma_f32 v94, -v180, v204, v94
    v_mul_f32 v94, v181, v94
    v_fma_f32 v95, -v182, v204, v95
    v_mul_f32 v95, v183, v95
    v_cvt_pk_bf16_f32 v92, v92, v93
    v_cvt_pk_bf16_f32 v93, v94, v95
    v_xor_b32 v92, s23, v92
    v_xor_b32 v93, s23, v93
    ds_write_b64 v7, v[92:93] offset:34848
    s_waitcnt lgkmcnt(0)
    v_mov_b32 v8, 157696
    v_mov_b32 v10, 1
    s_mov_b64 s[34:35], exec
    s_mov_b64 exec, 1
    ds_add_u32 v8, v10
    s_mov_b64 exec, s[34:35]
    s_waitcnt vmcnt(0)
    ds_read_b128 v[208:211], v9 offset:576
    v_lshlrev_b32 v140, 16, v130
    v_and_b32 v141, 0xffff0000, v130
    v_lshlrev_b32 v142, 16, v131
    v_and_b32 v143, 0xffff0000, v131
    s_waitcnt lgkmcnt(0)
    v_fma_f32 v96, -v168, v208, v96
    v_fma_f32 v96, v169, v96, v140
    v_max_f32 v96, 0, v96
    v_mul_f32 v96, v96, v96
    v_fma_f32 v97, -v168, v209, v97
    v_fma_f32 v97, v169, v97, v141
    v_max_f32 v97, 0, v97
    v_mul_f32 v97, v97, v97
    v_fma_f32 v98, -v168, v210, v98
    v_fma_f32 v98, v169, v98, v142
    v_max_f32 v98, 0, v98
    v_mul_f32 v98, v98, v98
    v_fma_f32 v99, -v168, v211, v99
    v_fma_f32 v99, v169, v99, v143
    v_max_f32 v99, 0, v99
    v_mul_f32 v99, v99, v99
    v_cvt_pk_bf16_f32 v96, v96, v97
    v_cvt_pk_bf16_f32 v97, v98, v99
    ds_write_b64 v11, v[96:97] offset:0
    v_fma_f32 v100, -v184, v208, v100
    v_fma_f32 v100, v185, v100, v140
    v_max_f32 v100, 0, v100
    v_mul_f32 v100, v100, v100
    v_fma_f32 v101, -v184, v209, v101
    v_fma_f32 v101, v185, v101, v141
    v_max_f32 v101, 0, v101
    v_mul_f32 v101, v101, v101
    v_fma_f32 v102, -v184, v210, v102
    v_fma_f32 v102, v185, v102, v142
    v_max_f32 v102, 0, v102
    v_mul_f32 v102, v102, v102
    v_fma_f32 v103, -v184, v211, v103
    v_fma_f32 v103, v185, v103, v143
    v_max_f32 v103, 0, v103
    v_mul_f32 v103, v103, v103
    v_cvt_pk_bf16_f32 v100, v100, v101
    v_cvt_pk_bf16_f32 v101, v102, v103
    ds_write_b64 v11, v[100:101] offset:5888
    ds_read_b128 v[208:211], v9 offset:640
    v_lshlrev_b32 v140, 16, v132
    v_and_b32 v141, 0xffff0000, v132
    v_lshlrev_b32 v142, 16, v133
    v_and_b32 v143, 0xffff0000, v133
    s_waitcnt lgkmcnt(0)
    v_fma_f32 v104, -v168, v208, v104
    v_fma_f32 v104, v169, v104, v140
    v_max_f32 v104, 0, v104
    v_mul_f32 v104, v104, v104
    v_fma_f32 v105, -v168, v209, v105
    v_fma_f32 v105, v169, v105, v141
    v_max_f32 v105, 0, v105
    v_mul_f32 v105, v105, v105
    v_fma_f32 v106, -v168, v210, v106
    v_fma_f32 v106, v169, v106, v142
    v_max_f32 v106, 0, v106
    v_mul_f32 v106, v106, v106
    v_fma_f32 v107, -v168, v211, v107
    v_fma_f32 v107, v169, v107, v143
    v_max_f32 v107, 0, v107
    v_mul_f32 v107, v107, v107
    v_cvt_pk_bf16_f32 v104, v104, v105
    v_cvt_pk_bf16_f32 v105, v106, v107
    ds_write_b64 v11, v[104:105] offset:32
    v_fma_f32 v108, -v184, v208, v108
    v_fma_f32 v108, v185, v108, v140
    v_max_f32 v108, 0, v108
    v_mul_f32 v108, v108, v108
    v_fma_f32 v109, -v184, v209, v109
    v_fma_f32 v109, v185, v109, v141
    v_max_f32 v109, 0, v109
    v_mul_f32 v109, v109, v109
    v_fma_f32 v110, -v184, v210, v110
    v_fma_f32 v110, v185, v110, v142
    v_max_f32 v110, 0, v110
    v_mul_f32 v110, v110, v110
    v_fma_f32 v111, -v184, v211, v111
    v_fma_f32 v111, v185, v111, v143
    v_max_f32 v111, 0, v111
    v_mul_f32 v111, v111, v111
    v_cvt_pk_bf16_f32 v108, v108, v109
    v_cvt_pk_bf16_f32 v109, v110, v111
    ds_write_b64 v11, v[108:109] offset:5920
    s_waitcnt lgkmcnt(0)
    s_sub_u32 s22, s21, 880
    s_lshl_b32 s22, s22, 1
    v_add_u32 v8, 0, v2
    v_lshrrev_b32 v10, 2, v8
    v_and_b32 v12, 3, v8
    s_lshl_b32 s23, s18, 5
    v_add_u32 v10, s23, v10
    v_mul_u32_u24 v13, 368, v10
    v_lshl_add_u32 v13, v12, 4, v13
    v_add_u32 v13, 0x10000, v13
    ds_read_b128 v[24:27], v13
    s_lshl_b32 s23, s16, 7
    v_add_u32 v10, s23, v10
    v_lshlrev_b32 v10, 12, v10
    v_lshl_add_u32 v10, v12, 4, v10
    v_add_u32 v112, s22, v10
    v_add_u32 v8, 64, v2
    v_lshrrev_b32 v10, 2, v8
    v_and_b32 v12, 3, v8
    s_lshl_b32 s23, s18, 5
    v_add_u32 v10, s23, v10
    v_mul_u32_u24 v13, 368, v10
    v_lshl_add_u32 v13, v12, 4, v13
    v_add_u32 v13, 0x10000, v13
    ds_read_b128 v[28:31], v13
    s_lshl_b32 s23, s16, 7
    v_add_u32 v10, s23, v10
    v_lshlrev_b32 v10, 12, v10
    v_lshl_add_u32 v10, v12, 4, v10
    v_add_u32 v113, s22, v10
    s_waitcnt lgkmcnt(1)
    buffer_store_dwordx4 v[24:27], v112, s[12:15], 0 offen
    s_waitcnt lgkmcnt(0)
    buffer_store_dwordx4 v[28:31], v113, s[12:15], 0 offen
    v_mov_b32 v8, 157696
g1_poll2_9:
    ds_read_b32 v9, v8
    s_waitcnt lgkmcnt(0)
    v_readfirstlane_b32 s22, v9
    s_nop 1
    s_cmp_lt_u32 s22, 4
    s_cbranch_scc1 g1_poll2_9
    s_lshl_b32 s22, s18, 6
    v_add_u32 v8, s22, v2
    v_lshrrev_b32 v10, 4, v8
    v_and_b32 v12, 15, v8
    v_mul_u32_u24 v13, 272, v10
    v_lshl_add_u32 v13, v12, 4, v13
    v_add_u32 v10, s21, v10
    v_lshlrev_b32 v10, 12, v10
    v_lshl_add_u32 v10, v12, 4, v10
    s_lshl_b32 s22, s16, 8
    v_add_u32 v10, s22, v10
    ds_read_b128 v[160:163], v13 offset:0
    ds_read_b128 v[164:167], v13 offset:4352
    ds_read_b128 v[168:171], v13 offset:8704
    ds_read_b128 v[172:175], v13 offset:13056
    ds_read_b128 v[176:179], v13 offset:17408
    ds_read_b128 v[180:183], v13 offset:21760
    ds_read_b128 v[184:187], v13 offset:26112
    ds_read_b128 v[188:191], v13 offset:30464
    ds_read_b128 v[192:195], v13 offset:34816
    s_waitcnt lgkmcnt(8)
    s_mov_b32 s22, 0x0
    buffer_store_dwordx4 v[160:163], v10, s[8:11], s22 offen
    s_waitcnt lgkmcnt(7)
    s_mov_b32 s22, 0x10000
    buffer_store_dwordx4 v[164:167], v10, s[8:11], s22 offen
    s_waitcnt lgkmcnt(6)
    s_mov_b32 s22, 0x20000
    buffer_store_dwordx4 v[168:171], v10, s[8:11], s22 offen
    s_waitcnt lgkmcnt(5)
    s_mov_b32 s22, 0x30000
    buffer_store_dwordx4 v[172:175], v10, s[8:11], s22 offen
    s_waitcnt lgkmcnt(4)
    s_mov_b32 s22, 0x40000
    buffer_store_dwordx4 v[176:179], v10, s[8:11], s22 offen
    s_waitcnt lgkmcnt(3)
    s_mov_b32 s22, 0x50000
    buffer_store_dwordx4 v[180:183], v10, s[8:11], s22 offen
    s_waitcnt lgkmcnt(2)
    s_mov_b32 s22, 0x60000
    buffer_store_dwordx4 v[184:187], v10, s[8:11], s22 offen
    s_waitcnt lgkmcnt(1)
    s_mov_b32 s22, 0x70000
    buffer_store_dwordx4 v[188:191], v10, s[8:11], s22 offen
    s_waitcnt lgkmcnt(0)
    s_mov_b32 s22, 0x80000
    buffer_store_dwordx4 v[192:195], v10, s[8:11], s22 offen
    s_waitcnt vmcnt(0)
    s_endpgm
g1_c_0:
    v_lshrrev_b32 v8, 2, v5
    v_lshl_add_u32 v8, v6, 3, v8
    v_mul_u32_u24 v8, 352, v8
    v_and_b32 v9, 3, v2
    v_lshl_add_u32 v8, v9, 3, v8
    v_add_u32 v19, 16384, v8
    s_barrier
    ds_read_b128 v[112:115], v20
    ds_read_b128 v[116:119], v20 offset:2048
    ds_read_b64_tr_b16 v[128:129], v19 offset:0
    ds_read_b64_tr_b16 v[130:131], v19 offset:1408
    ds_read_b64_tr_b16 v[132:133], v19 offset:32
    ds_read_b64_tr_b16 v[134:135], v19 offset:1440
    ds_read_b64_tr_b16 v[136:137], v19 offset:64
    ds_read_b64_tr_b16 v[138:139], v19 offset:1472
    ds_read_b64_tr_b16 v[140:141], v19 offset:96
    ds_read_b64_tr_b16 v[142:143], v19 offset:1504
    ds_read_b64_tr_b16 v[144:145], v19 offset:128
    ds_read_b64_tr_b16 v[146:147], v19 offset:1536
    ds_read_b64_tr_b16 v[148:149], v19 offset:160
    ds_read_b64_tr_b16 v[150:151], v19 offset:1568
    s_cmp_eq_u32 s18, 1
    s_cbranch_scc1 g1_loop_0_1
    s_cmp_eq_u32 s18, 2
    s_cbranch_scc1 g1_loop_0_2
    s_cmp_eq_u32 s18, 3
    s_cbranch_scc1 g1_loop_0_3
g1_loop_0_0:
    ds_read_b64_tr_b16 v[152:153], v19 offset:192
    ds_read_b64_tr_b16 v[154:155], v19 offset:1600
    s_waitcnt lgkmcnt(12)
    v_mfma_f32_16x16x32_bf16 v[24:27], v[128:131], v[112:115], v[24:27]
    v_mfma_f32_16x16x32_bf16 v[28:31], v[128:131], v[116:119], v[28:31]
    v_dot2c_f32_bf16 v212, s33, v128
    v_dot2c_f32_bf16 v212, s33, v129
    v_dot2c_f32_bf16 v212, s33, v130
    v_dot2c_f32_bf16 v212, s33, v131
    v_dot2c_f32_bf16 v216, s33, v112
    v_dot2c_f32_bf16 v217, v112, v112
    ds_read_b64_tr_b16 v[156:157], v19 offset:224
    ds_read_b64_tr_b16 v[158:159], v19 offset:1632
    s_waitcnt lgkmcnt(12)
    v_mfma_f32_16x16x32_bf16 v[32:35], v[132:135], v[112:115], v[32:35]
    v_mfma_f32_16x16x32_bf16 v[36:39], v[132:135], v[116:119], v[36:39]
    v_dot2c_f32_bf16 v216, s33, v113
    v_dot2c_f32_bf16 v217, v113, v113
    ds_read_b64_tr_b16 v[160:161], v19 offset:256
    ds_read_b64_tr_b16 v[162:163], v19 offset:1664
    s_waitcnt lgkmcnt(12)
    v_mfma_f32_16x16x32_bf16 v[40:43], v[136:139], v[112:115], v[40:43]
    v_mfma_f32_16x16x32_bf16 v[44:47], v[136:139], v[116:119], v[44:47]
    v_dot2c_f32_bf16 v216, s33, v114
    v_dot2c_f32_bf16 v217, v114, v114
    ds_read_b64_tr_b16 v[164:165], v19 offset:288
    ds_read_b64_tr_b16 v[166:167], v19 offset:1696
    s_waitcnt lgkmcnt(12)
    v_mfma_f32_16x16x32_bf16 v[48:51], v[140:143], v[112:115], v[48:51]
    v_mfma_f32_16x16x32_bf16 v[52:55], v[140:143], v[116:119], v[52:55]
    v_dot2c_f32_bf16 v216, s33, v115
    v_dot2c_f32_bf16 v217, v115, v115
    ds_read_b64_tr_b16 v[168:169], v19 offset:320
    ds_read_b64_tr_b16 v[170:171], v19 offset:1728
    s_waitcnt lgkmcnt(12)
    v_mfma_f32_16x16x32_bf16 v[56:59], v[144:147], v[112:115], v[56:59]
    v_mfma_f32_16x16x32_bf16 v[60:63], v[144:147], v[116:119], v[60:63]
    v_dot2c_f32_bf16 v213, s33, v144
    v_dot2c_f32_bf16 v213, s33, v145
    v_dot2c_f32_bf16 v213, s33, v146
    v_dot2c_f32_bf16 v213, s33, v147
    v_dot2c_f32_bf16 v218, s33, v116
    v_dot2c_f32_bf16 v219, v116, v116
    ds_read_b128 v[120:123], v21
    ds_read_b128 v[124:127], v21 offset:2048
    ds_read_b64_tr_b16 v[128:129], v19 offset:11264
    ds_read_b64_tr_b16 v[130:131], v19 offset:12672
    s_waitcnt lgkmcnt(14)
    v_mfma_f32_16x16x32_bf16 v[64:67], v[148:151], v[112:115], v[64:67]
    v_mfma_f32_16x16x32_bf16 v[68:71], v[148:151], v[116:119], v[68:71]
    v_dot2c_f32_bf16 v218, s33, v117
    v_dot2c_f32_bf16 v219, v117, v117
    ds_read_b64_tr_b16 v[132:133], v19 offset:11296
    ds_read_b64_tr_b16 v[134:135], v19 offset:12704
    s_waitcnt lgkmcnt(14)
    v_mfma_f32_16x16x32_bf16 v[72:75], v[152:155], v[112:115], v[72:75]
    v_mfma_f32_16x16x32_bf16 v[76:79], v[152:155], v[116:119], v[76:79]
    v_dot2c_f32_bf16 v218, s33, v118
    v_dot2c_f32_bf16 v219, v118, v118
    ds_read_b64_tr_b16 v[136:137], v19 offset:11328
    ds_read_b64_tr_b16 v[138:139], v19 offset:12736
    s_waitcnt lgkmcnt(14)
    v_mfma_f32_16x16x32_bf16 v[80:83], v[156:159], v[112:115], v[80:83]
    v_mfma_f32_16x16x32_bf16 v[84:87], v[156:159], v[116:119], v[84:87]
    v_dot2c_f32_bf16 v218, s33, v119
    v_dot2c_f32_bf16 v219, v119, v119
    ds_read_b64_tr_b16 v[140:141], v19 offset:11360
    ds_read_b64_tr_b16 v[142:143], v19 offset:12768
    s_waitcnt lgkmcnt(14)
    v_mfma_f32_16x16x32_bf16 v[88:91], v[160:163], v[112:115], v[88:91]
    v_mfma_f32_16x16x32_bf16 v[92:95], v[160:163], v[116:119], v[92:95]
    v_dot2c_f32_bf16 v214, s33, v160
    v_dot2c_f32_bf16 v214, s33, v161
    v_dot2c_f32_bf16 v214, s33, v162
    v_dot2c_f32_bf16 v214, s33, v163
    ds_read_b64_tr_b16 v[144:145], v19 offset:11392
    ds_read_b64_tr_b16 v[146:147], v19 offset:12800
    s_waitcnt lgkmcnt(14)
    v_mfma_f32_16x16x32_bf16 v[96:99], v[164:167], v[112:115], v[96:99]
    v_mfma_f32_16x16x32_bf16 v[100:103], v[164:167], v[116:119], v[100:103]
    ds_read_b64_tr_b16 v[148:149], v19 offset:11424
    ds_read_b64_tr_b16 v[150:151], v19 offset:12832
    s_waitcnt lgkmcnt(14)
    v_mfma_f32_16x16x32_bf16 v[104:107], v[168:171], v[112:115], v[104:107]
    v_mfma_f32_16x16x32_bf16 v[108:111], v[168:171], v[116:119], v[108:111]
    ds_read_b64_tr_b16 v[152:153], v19 offset:11456
    ds_read_b64_tr_b16 v[154:155], v19 offset:12864
    s_waitcnt lgkmcnt(12)
    v_mfma_f32_16x16x32_bf16 v[24:27], v[128:131], v[120:123], v[24:27]
    v_mfma_f32_16x16x32_bf16 v[28:31], v[128:131], v[124:127], v[28:31]
    v_dot2c_f32_bf16 v212, s33, v128
    v_dot2c_f32_bf16 v212, s33, v129
    v_dot2c_f32_bf16 v212, s33, v130
    v_dot2c_f32_bf16 v212, s33, v131
    v_dot2c_f32_bf16 v216, s33, v120
    v_dot2c_f32_bf16 v217, v120, v120
    ds_read_b64_tr_b16 v[156:157], v19 offset:11488
    ds_read_b64_tr_b16 v[158:159], v19 offset:12896
    s_waitcnt lgkmcnt(12)
    v_mfma_f32_16x16x32_bf16 v[32:35], v[132:135], v[120:123], v[32:35]
    v_mfma_f32_16x16x32_bf16 v[36:39], v[132:135], v[124:127], v[36:39]
    v_dot2c_f32_bf16 v216, s33, v121
    v_dot2c_f32_bf16 v217, v121, v121
    ds_read_b64_tr_b16 v[160:161], v19 offset:11520
    ds_read_b64_tr_b16 v[162:163], v19 offset:12928
    s_waitcnt lgkmcnt(12)
    v_mfma_f32_16x16x32_bf16 v[40:43], v[136:139], v[120:123], v[40:43]
    v_mfma_f32_16x16x32_bf16 v[44:47], v[136:139], v[124:127], v[44:47]
    v_dot2c_f32_bf16 v216, s33, v122
    v_dot2c_f32_bf16 v217, v122, v122
    ds_read_b64_tr_b16 v[164:165], v19 offset:11552
    ds_read_b64_tr_b16 v[166:167], v19 offset:12960
    s_waitcnt lgkmcnt(12)
    v_mfma_f32_16x16x32_bf16 v[48:51], v[140:143], v[120:123], v[48:51]
    v_mfma_f32_16x16x32_bf16 v[52:55], v[140:143], v[124:127], v[52:55]
    v_dot2c_f32_bf16 v216, s33, v123
    v_dot2c_f32_bf16 v217, v123, v123
    ds_read_b64_tr_b16 v[168:169], v19 offset:11584
    ds_read_b64_tr_b16 v[170:171], v19 offset:12992
    s_waitcnt lgkmcnt(12)
    v_mfma_f32_16x16x32_bf16 v[56:59], v[144:147], v[120:123], v[56:59]
    v_mfma_f32_16x16x32_bf16 v[60:63], v[144:147], v[124:127], v[60:63]
    v_dot2c_f32_bf16 v213, s33, v144
    v_dot2c_f32_bf16 v213, s33, v145
    v_dot2c_f32_bf16 v213, s33, v146
    v_dot2c_f32_bf16 v213, s33, v147
    v_dot2c_f32_bf16 v218, s33, v124
    v_dot2c_f32_bf16 v219, v124, v124
    s_barrier
    s_add_u32 s28, s28, 38912
    s_cmp_ge_u32 s28, 155648
    s_cselect_b32 s34, 155648, 0
    s_cselect_b32 s28, 0, s28
    s_sub_u32 s34, 38912, s34
    v_add_u32 v20, s34, v20
    v_add_u32 v21, s34, v21
    v_add_u32 v22, s34, v22
    v_add_u32 v23, s34, v23
    v_add_u32 v19, s34, v19
    ds_read_b128 v[112:115], v20
    ds_read_b128 v[116:119], v20 offset:2048
    ds_read_b64_tr_b16 v[128:129], v19 offset:0
    ds_read_b64_tr_b16 v[130:131], v19 offset:1408
    s_waitcnt lgkmcnt(14)
    v_mfma_f32_16x16x32_bf16 v[64:67], v[148:151], v[120:123], v[64:67]
    v_mfma_f32_16x16x32_bf16 v[68:71], v[148:151], v[124:127], v[68:71]
    v_dot2c_f32_bf16 v218, s33, v125
    v_dot2c_f32_bf16 v219, v125, v125
    ds_read_b64_tr_b16 v[132:133], v19 offset:32
    ds_read_b64_tr_b16 v[134:135], v19 offset:1440
    s_waitcnt lgkmcnt(14)
    v_mfma_f32_16x16x32_bf16 v[72:75], v[152:155], v[120:123], v[72:75]
    v_mfma_f32_16x16x32_bf16 v[76:79], v[152:155], v[124:127], v[76:79]
    v_dot2c_f32_bf16 v218, s33, v126
    v_dot2c_f32_bf16 v219, v126, v126
    ds_read_b64_tr_b16 v[136:137], v19 offset:64
    ds_read_b64_tr_b16 v[138:139], v19 offset:1472
    s_waitcnt lgkmcnt(14)
    v_mfma_f32_16x16x32_bf16 v[80:83], v[156:159], v[120:123], v[80:83]
    v_mfma_f32_16x16x32_bf16 v[84:87], v[156:159], v[124:127], v[84:87]
    v_dot2c_f32_bf16 v218, s33, v127
    v_dot2c_f32_bf16 v219, v127, v127
    ds_read_b64_tr_b16 v[140:141], v19 offset:96
    ds_read_b64_tr_b16 v[142:143], v19 offset:1504
    s_waitcnt lgkmcnt(14)
    v_mfma_f32_16x16x32_bf16 v[88:91], v[160:163], v[120:123], v[88:91]
    v_mfma_f32_16x16x32_bf16 v[92:95], v[160:163], v[124:127], v[92:95]
    v_dot2c_f32_bf16 v214, s33, v160
    v_dot2c_f32_bf16 v214, s33, v161
    v_dot2c_f32_bf16 v214, s33, v162
    v_dot2c_f32_bf16 v214, s33, v163
    ds_read_b64_tr_b16 v[144:145], v19 offset:128
    ds_read_b64_tr_b16 v[146:147], v19 offset:1536
    s_waitcnt lgkmcnt(14)
    v_mfma_f32_16x16x32_bf16 v[96:99], v[164:167], v[120:123], v[96:99]
    v_mfma_f32_16x16x32_bf16 v[100:103], v[164:167], v[124:127], v[100:103]
    ds_read_b64_tr_b16 v[148:149], v19 offset:160
    ds_read_b64_tr_b16 v[150:151], v19 offset:1568
    s_waitcnt lgkmcnt(14)
    v_mfma_f32_16x16x32_bf16 v[104:107], v[168:171], v[120:123], v[104:107]
    v_mfma_f32_16x16x32_bf16 v[108:111], v[168:171], v[124:127], v[108:111]
    s_add_u32 s32, s32, 1
    s_cmp_lt_u32 s32, 8
    s_cbranch_scc1 g1_loop_0_0
    s_branch g1_post_0
g1_loop_0_1:
    ds_read_b64_tr_b16 v[152:153], v19 offset:192
    ds_read_b64_tr_b16 v[154:155], v19 offset:1600
    s_waitcnt lgkmcnt(12)
    v_mfma_f32_16x16x32_bf16 v[24:27], v[128:131], v[112:115], v[24:27]
    v_mfma_f32_16x16x32_bf16 v[28:31], v[128:131], v[116:119], v[28:31]
    v_dot2c_f32_bf16 v216, s33, v112
    v_dot2c_f32_bf16 v217, v112, v112
    ds_read_b64_tr_b16 v[156:157], v19 offset:224
    ds_read_b64_tr_b16 v[158:159], v19 offset:1632
    s_waitcnt lgkmcnt(12)
    v_mfma_f32_16x16x32_bf16 v[32:35], v[132:135], v[112:115], v[32:35]
    v_mfma_f32_16x16x32_bf16 v[36:39], v[132:135], v[116:119], v[36:39]
    v_dot2c_f32_bf16 v212, s33, v132
    v_dot2c_f32_bf16 v212, s33, v133
    v_dot2c_f32_bf16 v212, s33, v134
    v_dot2c_f32_bf16 v212, s33, v135
    v_dot2c_f32_bf16 v216, s33, v113
    v_dot2c_f32_bf16 v217, v113, v113
    ds_read_b64_tr_b16 v[160:161], v19 offset:256
    ds_read_b64_tr_b16 v[162:163], v19 offset:1664
    s_waitcnt lgkmcnt(12)
    v_mfma_f32_16x16x32_bf16 v[40:43], v[136:139], v[112:115], v[40:43]
    v_mfma_f32_16x16x32_bf16 v[44:47], v[136:139], v[116:119], v[44:47]
    v_dot2c_f32_bf16 v216, s33, v114
    v_dot2c_f32_bf16 v217, v114, v114
    ds_read_b64_tr_b16 v[164:165], v19 offset:288
    ds_read_b64_tr_b16 v[166:167], v19 offset:1696
    s_waitcnt lgkmcnt(12)
    v_mfma_f32_16x16x32_bf16 v[48:51], v[140:143], v[112:115], v[48:51]
    v_mfma_f32_16x16x32_bf16 v[52:55], v[140:143], v[116:119], v[52:55]
    v_dot2c_f32_bf16 v216, s33, v115
    v_dot2c_f32_bf16 v217, v115, v115
    ds_read_b64_tr_b16 v[168:169], v19 offset:320
    ds_read_b64_tr_b16 v[170:171], v19 offset:1728
    s_waitcnt lgkmcnt(12)
    v_mfma_f32_16x16x32_bf16 v[56:59], v[144:147], v[112:115], v[56:59]
    v_mfma_f32_16x16x32_bf16 v[60:63], v[144:147], v[116:119], v[60:63]
    v_dot2c_f32_bf16 v218, s33, v116
    v_dot2c_f32_bf16 v219, v116, v116
    ds_read_b128 v[120:123], v21
    ds_read_b128 v[124:127], v21 offset:2048
    ds_read_b64_tr_b16 v[128:129], v19 offset:11264
    ds_read_b64_tr_b16 v[130:131], v19 offset:12672
    s_waitcnt lgkmcnt(14)
    v_mfma_f32_16x16x32_bf16 v[64:67], v[148:151], v[112:115], v[64:67]
    v_mfma_f32_16x16x32_bf16 v[68:71], v[148:151], v[116:119], v[68:71]
    v_dot2c_f32_bf16 v213, s33, v148
    v_dot2c_f32_bf16 v213, s33, v149
    v_dot2c_f32_bf16 v213, s33, v150
    v_dot2c_f32_bf16 v213, s33, v151
    v_dot2c_f32_bf16 v218, s33, v117
    v_dot2c_f32_bf16 v219, v117, v117
    ds_read_b64_tr_b16 v[132:133], v19 offset:11296
    ds_read_b64_tr_b16 v[134:135], v19 offset:12704
    s_waitcnt lgkmcnt(14)
    v_mfma_f32_16x16x32_bf16 v[72:75], v[152:155], v[112:115], v[72:75]
    v_mfma_f32_16x16x32_bf16 v[76:79], v[152:155], v[116:119], v[76:79]
    v_dot2c_f32_bf16 v218, s33, v118
    v_dot2c_f32_bf16 v219, v118, v118
    ds_read_b64_tr_b16 v[136:137], v19 offset:11328
    ds_read_b64_tr_b16 v[138:139], v19 offset:12736
    s_waitcnt lgkmcnt(14)
    v_mfma_f32_16x16x32_bf16 v[80:83], v[156:159], v[112:115], v[80:83]
    v_mfma_f32_16x16x32_bf16 v[84:87], v[156:159], v[116:119], v[84:87]
    v_dot2c_f32_bf16 v218, s33, v119
    v_dot2c_f32_bf16 v219, v119, v119
    ds_read_b64_tr_b16 v[140:141], v19 offset:11360
    ds_read_b64_tr_b16 v[142:143], v19 offset:12768
    s_waitcnt lgkmcnt(14)
    v_mfma_f32_16x16x32_bf16 v[88:91], v[160:163], v[112:115], v[88:91]
    v_mfma_f32_16x16x32_bf16 v[92:95], v[160:163], v[116:119], v[92:95]
    ds_read_b64_tr_b16 v[144:145], v19 offset:11392
    ds_read_b64_tr_b16 v[146:147], v19 offset:12800
    s_waitcnt lgkmcnt(14)
    v_mfma_f32_16x16x32_bf16 v[96:99], v[164:167], v[112:115], v[96:99]
    v_mfma_f32_16x16x32_bf16 v[100:103], v[164:167], v[116:119], v[100:103]
    v_dot2c_f32_bf16 v214, s33, v164
    v_dot2c_f32_bf16 v214, s33, v165
    v_dot2c_f32_bf16 v214, s33, v166
    v_dot2c_f32_bf16 v214, s33, v167
    ds_read_b64_tr_b16 v[148:149], v19 offset:11424
    ds_read_b64_tr_b16 v[150:151], v19 offset:12832
    s_waitcnt lgkmcnt(14)
    v_mfma_f32_16x16x32_bf16 v[104:107], v[168:171], v[112:115], v[104:107]
    v_mfma_f32_16x16x32_bf16 v[108:111], v[168:171], v[116:119], v[108:111]
    ds_read_b64_tr_b16 v[152:153], v19 offset:11456
    ds_read_b64_tr_b16 v[154:155], v19 offset:12864
    s_waitcnt lgkmcnt(12)
    v_mfma_f32_16x16x32_bf16 v[24:27], v[128:131], v[120:123], v[24:27]
    v_mfma_f32_16x16x32_bf16 v[28:31], v[128:131], v[124:127], v[28:31]
    v_dot2c_f32_bf16 v216, s33, v120
    v_dot2c_f32_bf16 v217, v120, v120
    ds_read_b64_tr_b16 v[156:157], v19 offset:11488
    ds_read_b64_tr_b16 v[158:159], v19 offset:12896
    s_waitcnt lgkmcnt(12)
    v_mfma_f32_16x16x32_bf16 v[32:35], v[132:135], v[120:123], v[32:35]
    v_mfma_f32_16x16x32_bf16 v[36:39], v[132:135], v[124:127], v[36:39]
    v_dot2c_f32_bf16 v212, s33, v132
    v_dot2c_f32_bf16 v212, s33, v133
    v_dot2c_f32_bf16 v212, s33, v134
    v_dot2c_f32_bf16 v212, s33, v135
    v_dot2c_f32_bf16 v216, s33, v121
    v_dot2c_f32_bf16 v217, v121, v121
    ds_read_b64_tr_b16 v[160:161], v19 offset:11520
    ds_read_b64_tr_b16 v[162:163], v19 offset:12928
    s_waitcnt lgkmcnt(12)
    v_mfma_f32_16x16x32_bf16 v[40:43], v[136:139], v[120:123], v[40:43]
    v_mfma_f32_16x16x32_bf16 v[44:47], v[136:139], v[124:127], v[44:47]
    v_dot2c_f32_bf16 v216, s33, v122
    v_dot2c_f32_bf16 v217, v122, v122
    ds_read_b64_tr_b16 v[164:165], v19 offset:11552
    ds_read_b64_tr_b16 v[166:167], v19 offset:12960
    s_waitcnt lgkmcnt(12)
    v_mfma_f32_16x16x32_bf16 v[48:51], v[140:143], v[120:123], v[48:51]
    v_mfma_f32_16x16x32_bf16 v[52:55], v[140:143], v[124:127], v[52:55]
    v_dot2c_f32_bf16 v216, s33, v123
    v_dot2c_f32_bf16 v217, v123, v123
    ds_read_b64_tr_b16 v[168:169], v19 offset:11584
    ds_read_b64_tr_b16 v[170:171], v19 offset:12992
    s_waitcnt lgkmcnt(12)
    v_mfma_f32_16x16x32_bf16 v[56:59], v[144:147], v[120:123], v[56:59]
    v_mfma_f32_16x16x32_bf16 v[60:63], v[144:147], v[124:127], v[60:63]
    v_dot2c_f32_bf16 v218, s33, v124
    v_dot2c_f32_bf16 v219, v124, v124
    s_barrier
    s_add_u32 s28, s28, 38912
    s_cmp_ge_u32 s28, 155648
    s_cselect_b32 s34, 155648, 0
    s_cselect_b32 s28, 0, s28
    s_sub_u32 s34, 38912, s34
    v_add_u32 v20, s34, v20
    v_add_u32 v21, s34, v21
    v_add_u32 v22, s34, v22
    v_add_u32 v23, s34, v23
    v_add_u32 v19, s34, v19
    ds_read_b128 v[112:115], v20
    ds_read_b128 v[116:119], v20 offset:2048
    ds_read_b64_tr_b16 v[128:129], v19 offset:0
    ds_read_b64_tr_b16 v[130:131], v19 offset:1408
    s_waitcnt lgkmcnt(14)
    v_mfma_f32_16x16x32_bf16 v[64:67], v[148:151], v[120:123], v[64:67]
    v_mfma_f32_16x16x32_bf16 v[68:71], v[148:151], v[124:127], v[68:71]
    v_dot2c_f32_bf16 v213, s33, v148
    v_dot2c_f32_bf16 v213, s33, v149
    v_dot2c_f32_bf16 v213, s33, v150
    v_dot2c_f32_bf16 v213, s33, v151
    v_dot2c_f32_bf16 v218, s33, v125
    v_dot2c_f32_bf16 v219, v125, v125
    ds_read_b64_tr_b16 v[132:133], v19 offset:32
    ds_read_b64_tr_b16 v[134:135], v19 offset:1440
    s_waitcnt lgkmcnt(14)
    v_mfma_f32_16x16x32_bf16 v[72:75], v[152:155], v[120:123], v[72:75]
    v_mfma_f32_16x16x32_bf16 v[76:79], v[152:155], v[124:127], v[76:79]
    v_dot2c_f32_bf16 v218, s33, v126
    v_dot2c_f32_bf16 v219, v126, v126
    ds_read_b64_tr_b16 v[136:137], v19 offset:64
    ds_read_b64_tr_b16 v[138:139], v19 offset:1472
    s_waitcnt lgkmcnt(14)
    v_mfma_f32_16x16x32_bf16 v[80:83], v[156:159], v[120:123], v[80:83]
    v_mfma_f32_16x16x32_bf16 v[84:87], v[156:159], v[124:127], v[84:87]
    v_dot2c_f32_bf16 v218, s33, v127
    v_dot2c_f32_bf16 v219, v127, v127
    ds_read_b64_tr_b16 v[140:141], v19 offset:96
    ds_read_b64_tr_b16 v[142:143], v19 offset:1504
    s_waitcnt lgkmcnt(14)
    v_mfma_f32_16x16x32_bf16 v[88:91], v[160:163], v[120:123], v[88:91]
    v_mfma_f32_16x16x32_bf16 v[92:95], v[160:163], v[124:127], v[92:95]
    ds_read_b64_tr_b16 v[144:145], v19 offset:128
    ds_read_b64_tr_b16 v[146:147], v19 offset:1536
    s_waitcnt lgkmcnt(14)
    v_mfma_f32_16x16x32_bf16 v[96:99], v[164:167], v[120:123], v[96:99]
    v_mfma_f32_16x16x32_bf16 v[100:103], v[164:167], v[124:127], v[100:103]
    v_dot2c_f32_bf16 v214, s33, v164
    v_dot2c_f32_bf16 v214, s33, v165
    v_dot2c_f32_bf16 v214, s33, v166
    v_dot2c_f32_bf16 v214, s33, v167
    ds_read_b64_tr_b16 v[148:149], v19 offset:160
    ds_read_b64_tr_b16 v[150:151], v19 offset:1568
    s_waitcnt lgkmcnt(14)
    v_mfma_f32_16x16x32_bf16 v[104:107], v[168:171], v[120:123], v[104:107]
    v_mfma_f32_16x16x32_bf16 v[108:111], v[168:171], v[124:127], v[108:111]
    s_add_u32 s32, s32, 1
    s_cmp_lt_u32 s32, 8
    s_cbranch_scc1 g1_loop_0_1
    s_branch g1_post_0
g1_loop_0_2:
    ds_read_b64_tr_b16 v[152:153], v19 offset:192
    ds_read_b64_tr_b16 v[154:155], v19 offset:1600
    s_waitcnt lgkmcnt(12)
    v_mfma_f32_16x16x32_bf16 v[24:27], v[128:131], v[112:115], v[24:27]
    v_mfma_f32_16x16x32_bf16 v[28:31], v[128:131], v[116:119], v[28:31]
    v_dot2c_f32_bf16 v216, s33, v112
    v_dot2c_f32_bf16 v217, v112, v112
    ds_read_b64_tr_b16 v[156:157], v19 offset:224
    ds_read_b64_tr_b16 v[158:159], v19 offset:1632
    s_waitcnt lgkmcnt(12)
    v_mfma_f32_16x16x32_bf16 v[32:35], v[132:135], v[112:115], v[32:35]
    v_mfma_f32_16x16x32_bf16 v[36:39], v[132:135], v[116:119], v[36:39]
    v_dot2c_f32_bf16 v216, s33, v113
    v_dot2c_f32_bf16 v217, v113, v113
    ds_read_b64_tr_b16 v[160:161], v19 offset:256
    ds_read_b64_tr_b16 v[162:163], v19 offset:1664
    s_waitcnt lgkmcnt(12)
    v_mfma_f32_16x16x32_bf16 v[40:43], v[136:139], v[112:115], v[40:43]
    v_mfma_f32_16x16x32_bf16 v[44:47], v[136:139], v[116:119], v[44:47]
    v_dot2c_f32_bf16 v212, s33, v136
    v_dot2c_f32_bf16 v212, s33, v137
    v_dot2c_f32_bf16 v212, s33, v138
    v_dot2c_f32_bf16 v212, s33, v139
    v_dot2c_f32_bf16 v216, s33, v114
    v_dot2c_f32_bf16 v217, v114, v114
    ds_read_b64_tr_b16 v[164:165], v19 offset:288
    ds_read_b64_tr_b16 v[166:167], v19 offset:1696
    s_waitcnt lgkmcnt(12)
    v_mfma_f32_16x16x32_bf16 v[48:51], v[140:143], v[112:115], v[48:51]
    v_mfma_f32_16x16x32_bf16 v[52:55], v[140:143], v[116:119], v[52:55]
    v_dot2c_f32_bf16 v216, s33, v115
    v_dot2c_f32_bf16 v217, v115, v115
    ds_read_b64_tr_b16 v[168:169], v19 offset:320
    ds_read_b64_tr_b16 v[170:171], v19 offset:1728
    s_waitcnt lgkmcnt(12)
    v_mfma_f32_16x16x32_bf16 v[56:59], v[144:147], v[112:115], v[56:59]
    v_mfma_f32_16x16x32_bf16 v[60:63], v[144:147], v[116:119], v[60:63]
    v_dot2c_f32_bf16 v218, s33, v116
    v_dot2c_f32_bf16 v219, v116, v116
    ds_read_b128 v[120:123], v21
    ds_read_b128 v[124:127], v21 offset:2048
    ds_read_b64_tr_b16 v[128:129], v19 offset:11264
    ds_read_b64_tr_b16 v[130:131], v19 offset:12672
    s_waitcnt lgkmcnt(14)
    v_mfma_f32_16x16x32_bf16 v[64:67], v[148:151], v[112:115], v[64:67]
    v_mfma_f32_16x16x32_bf16 v[68:71], v[148:151], v[116:119], v[68:71]
    v_dot2c_f32_bf16 v218, s33, v117
    v_dot2c_f32_bf16 v219, v117, v117
    ds_read_b64_tr_b16 v[132:133], v19 offset:11296
    ds_read_b64_tr_b16 v[134:135], v19 offset:12704
    s_waitcnt lgkmcnt(14)
    v_mfma_f32_16x16x32_bf16 v[72:75], v[152:155], v[112:115], v[72:75]
    v_mfma_f32_16x16x32_bf16 v[76:79], v[152:155], v[116:119], v[76:79]
    v_dot2c_f32_bf16 v213, s33, v152
    v_dot2c_f32_bf16 v213, s33, v153
    v_dot2c_f32_bf16 v213, s33, v154
    v_dot2c_f32_bf16 v213, s33, v155
    v_dot2c_f32_bf16 v218, s33, v118
    v_dot2c_f32_bf16 v219, v118, v118
    ds_read_b64_tr_b16 v[136:137], v19 offset:11328
    ds_read_b64_tr_b16 v[138:139], v19 offset:12736
    s_waitcnt lgkmcnt(14)
    v_mfma_f32_16x16x32_bf16 v[80:83], v[156:159], v[112:115], v[80:83]
    v_mfma_f32_16x16x32_bf16 v[84:87], v[156:159], v[116:119], v[84:87]
    v_dot2c_f32_bf16 v218, s33, v119
    v_dot2c_f32_bf16 v219, v119, v119
    ds_read_b64_tr_b16 v[140:141], v19 offset:11360
    ds_read_b64_tr_b16 v[142:143], v19 offset:12768
    s_waitcnt lgkmcnt(14)
    v_mfma_f32_16x16x32_bf16 v[88:91], v[160:163], v[112:115], v[88:91]
    v_mfma_f32_16x16x32_bf16 v[92:95], v[160:163], v[116:119], v[92:95]
    ds_read_b64_tr_b16 v[144:145], v19 offset:11392
    ds_read_b64_tr_b16 v[146:147], v19 offset:12800
    s_waitcnt lgkmcnt(14)
    v_mfma_f32_16x16x32_bf16 v[96:99], v[164:167], v[112:115], v[96:99]
    v_mfma_f32_16x16x32_bf16 v[100:103], v[164:167], v[116:119], v[100:103]
    ds_read_b64_tr_b16 v[148:149], v19 offset:11424
    ds_read_b64_tr_b16 v[150:151], v19 offset:12832
    s_waitcnt lgkmcnt(14)
    v_mfma_f32_16x16x32_bf16 v[104:107], v[168:171], v[112:115], v[104:107]
    v_mfma_f32_16x16x32_bf16 v[108:111], v[168:171], v[116:119], v[108:111]
    v_dot2c_f32_bf16 v214, s33, v168
    v_dot2c_f32_bf16 v214, s33, v169
    v_dot2c_f32_bf16 v214, s33, v170
    v_dot2c_f32_bf16 v214, s33, v171
    ds_read_b64_tr_b16 v[152:153], v19 offset:11456
    ds_read_b64_tr_b16 v[154:155], v19 offset:12864
    s_waitcnt lgkmcnt(12)
    v_mfma_f32_16x16x32_bf16 v[24:27], v[128:131], v[120:123], v[24:27]
    v_mfma_f32_16x16x32_bf16 v[28:31], v[128:131], v[124:127], v[28:31]
    v_dot2c_f32_bf16 v216, s33, v120
    v_dot2c_f32_bf16 v217, v120, v120
    ds_read_b64_tr_b16 v[156:157], v19 offset:11488
    ds_read_b64_tr_b16 v[158:159], v19 offset:12896
    s_waitcnt lgkmcnt(12)
    v_mfma_f32_16x16x32_bf16 v[32:35], v[132:135], v[120:123], v[32:35]
    v_mfma_f32_16x16x32_bf16 v[36:39], v[132:135], v[124:127], v[36:39]
    v_dot2c_f32_bf16 v216, s33, v121
    v_dot2c_f32_bf16 v217, v121, v121
    ds_read_b64_tr_b16 v[160:161], v19 offset:11520
    ds_read_b64_tr_b16 v[162:163], v19 offset:12928
    s_waitcnt lgkmcnt(12)
    v_mfma_f32_16x16x32_bf16 v[40:43], v[136:139], v[120:123], v[40:43]
    v_mfma_f32_16x16x32_bf16 v[44:47], v[136:139], v[124:127], v[44:47]
    v_dot2c_f32_bf16 v212, s33, v136
    v_dot2c_f32_bf16 v212, s33, v137
    v_dot2c_f32_bf16 v212, s33, v138
    v_dot2c_f32_bf16 v212, s33, v139
    v_dot2c_f32_bf16 v216, s33, v122
    v_dot2c_f32_bf16 v217, v122, v122
    ds_read_b64_tr_b16 v[164:165], v19 offset:11552
    ds_read_b64_tr_b16 v[166:167], v19 offset:12960
    s_waitcnt lgkmcnt(12)
    v_mfma_f32_16x16x32_bf16 v[48:51], v[140:143], v[120:123], v[48:51]
    v_mfma_f32_16x16x32_bf16 v[52:55], v[140:143], v[124:127], v[52:55]
    v_dot2c_f32_bf16 v216, s33, v123
    v_dot2c_f32_bf16 v217, v123, v123
    ds_read_b64_tr_b16 v[168:169], v19 offset:11584
    ds_read_b64_tr_b16 v[170:171], v19 offset:12992
    s_waitcnt lgkmcnt(12)
    v_mfma_f32_16x16x32_bf16 v[56:59], v[144:147], v[120:123], v[56:59]
    v_mfma_f32_16x16x32_bf16 v[60:63], v[144:147], v[124:127], v[60:63]
    v_dot2c_f32_bf16 v218, s33, v124
    v_dot2c_f32_bf16 v219, v124, v124
    s_barrier
    s_add_u32 s28, s28, 38912
    s_cmp_ge_u32 s28, 155648
    s_cselect_b32 s34, 155648, 0
    s_cselect_b32 s28, 0, s28
    s_sub_u32 s34, 38912, s34
    v_add_u32 v20, s34, v20
    v_add_u32 v21, s34, v21
    v_add_u32 v22, s34, v22
    v_add_u32 v23, s34, v23
    v_add_u32 v19, s34, v19
    ds_read_b128 v[112:115], v20
    ds_read_b128 v[116:119], v20 offset:2048
    ds_read_b64_tr_b16 v[128:129], v19 offset:0
    ds_read_b64_tr_b16 v[130:131], v19 offset:1408
    s_waitcnt lgkmcnt(14)
    v_mfma_f32_16x16x32_bf16 v[64:67], v[148:151], v[120:123], v[64:67]
    v_mfma_f32_16x16x32_bf16 v[68:71], v[148:151], v[124:127], v[68:71]
    v_dot2c_f32_bf16 v218, s33, v125
    v_dot2c_f32_bf16 v219, v125, v125
    ds_read_b64_tr_b16 v[132:133], v19 offset:32
    ds_read_b64_tr_b16 v[134:135], v19 offset:1440
    s_waitcnt lgkmcnt(14)
    v_mfma_f32_16x16x32_bf16 v[72:75], v[152:155], v[120:123], v[72:75]
    v_mfma_f32_16x16x32_bf16 v[76:79], v[152:155], v[124:127], v[76:79]
    v_dot2c_f32_bf16 v213, s33, v152
    v_dot2c_f32_bf16 v213, s33, v153
    v_dot2c_f32_bf16 v213, s33, v154
    v_dot2c_f32_bf16 v213, s33, v155
    v_dot2c_f32_bf16 v218, s33, v126
    v_dot2c_f32_bf16 v219, v126, v126
    ds_read_b64_tr_b16 v[136:137], v19 offset:64
    ds_read_b64_tr_b16 v[138:139], v19 offset:1472
    s_waitcnt lgkmcnt(14)
    v_mfma_f32_16x16x32_bf16 v[80:83], v[156:159], v[120:123], v[80:83]
    v_mfma_f32_16x16x32_bf16 v[84:87], v[156:159], v[124:127], v[84:87]
    v_dot2c_f32_bf16 v218, s33, v127
    v_dot2c_f32_bf16 v219, v127, v127
    ds_read_b64_tr_b16 v[140:141], v19 offset:96
    ds_read_b64_tr_b16 v[142:143], v19 offset:1504
    s_waitcnt lgkmcnt(14)
    v_mfma_f32_16x16x32_bf16 v[88:91], v[160:163], v[120:123], v[88:91]
    v_mfma_f32_16x16x32_bf16 v[92:95], v[160:163], v[124:127], v[92:95]
    ds_read_b64_tr_b16 v[144:145], v19 offset:128
    ds_read_b64_tr_b16 v[146:147], v19 offset:1536
    s_waitcnt lgkmcnt(14)
    v_mfma_f32_16x16x32_bf16 v[96:99], v[164:167], v[120:123], v[96:99]
    v_mfma_f32_16x16x32_bf16 v[100:103], v[164:167], v[124:127], v[100:103]
    ds_read_b64_tr_b16 v[148:149], v19 offset:160
    ds_read_b64_tr_b16 v[150:151], v19 offset:1568
    s_waitcnt lgkmcnt(14)
    v_mfma_f32_16x16x32_bf16 v[104:107], v[168:171], v[120:123], v[104:107]
    v_mfma_f32_16x16x32_bf16 v[108:111], v[168:171], v[124:127], v[108:111]
    v_dot2c_f32_bf16 v214, s33, v168
    v_dot2c_f32_bf16 v214, s33, v169
    v_dot2c_f32_bf16 v214, s33, v170
    v_dot2c_f32_bf16 v214, s33, v171
    s_add_u32 s32, s32, 1
    s_cmp_lt_u32 s32, 8
    s_cbranch_scc1 g1_loop_0_2
    s_branch g1_post_0
g1_loop_0_3:
    ds_read_b64_tr_b16 v[152:153], v19 offset:192
    ds_read_b64_tr_b16 v[154:155], v19 offset:1600
    s_waitcnt lgkmcnt(12)
    v_mfma_f32_16x16x32_bf16 v[24:27], v[128:131], v[112:115], v[24:27]
    v_mfma_f32_16x16x32_bf16 v[28:31], v[128:131], v[116:119], v[28:31]
    v_dot2c_f32_bf16 v216, s33, v112
    v_dot2c_f32_bf16 v217, v112, v112
    ds_read_b64_tr_b16 v[156:157], v19 offset:224
    ds_read_b64_tr_b16 v[158:159], v19 offset:1632
    s_waitcnt lgkmcnt(12)
    v_mfma_f32_16x16x32_bf16 v[32:35], v[132:135], v[112:115], v[32:35]
    v_mfma_f32_16x16x32_bf16 v[36:39], v[132:135], v[116:119], v[36:39]
    v_dot2c_f32_bf16 v216, s33, v113
    v_dot2c_f32_bf16 v217, v113, v113
    ds_read_b64_tr_b16 v[160:161], v19 offset:256
    ds_read_b64_tr_b16 v[162:163], v19 offset:1664
    s_waitcnt lgkmcnt(12)
    v_mfma_f32_16x16x32_bf16 v[40:43], v[136:139], v[112:115], v[40:43]
    v_mfma_f32_16x16x32_bf16 v[44:47], v[136:139], v[116:119], v[44:47]
    v_dot2c_f32_bf16 v216, s33, v114
    v_dot2c_f32_bf16 v217, v114, v114
    ds_read_b64_tr_b16 v[164:165], v19 offset:288
    ds_read_b64_tr_b16 v[166:167], v19 offset:1696
    s_waitcnt lgkmcnt(12)
    v_mfma_f32_16x16x32_bf16 v[48:51], v[140:143], v[112:115], v[48:51]
    v_mfma_f32_16x16x32_bf16 v[52:55], v[140:143], v[116:119], v[52:55]
    v_dot2c_f32_bf16 v212, s33, v140
    v_dot2c_f32_bf16 v212, s33, v141
    v_dot2c_f32_bf16 v212, s33, v142
    v_dot2c_f32_bf16 v212, s33, v143
    v_dot2c_f32_bf16 v216, s33, v115
    v_dot2c_f32_bf16 v217, v115, v115
    ds_read_b64_tr_b16 v[168:169], v19 offset:320
    ds_read_b64_tr_b16 v[170:171], v19 offset:1728
    s_waitcnt lgkmcnt(12)
    v_mfma_f32_16x16x32_bf16 v[56:59], v[144:147], v[112:115], v[56:59]
    v_mfma_f32_16x16x32_bf16 v[60:63], v[144:147], v[116:119], v[60:63]
    v_dot2c_f32_bf16 v218, s33, v116
    v_dot2c_f32_bf16 v219, v116, v116
    ds_read_b128 v[120:123], v21
    ds_read_b128 v[124:127], v21 offset:2048
    ds_read_b64_tr_b16 v[128:129], v19 offset:11264
    ds_read_b64_tr_b16 v[130:131], v19 offset:12672
    s_waitcnt lgkmcnt(14)
    v_mfma_f32_16x16x32_bf16 v[64:67], v[148:151], v[112:115], v[64:67]
    v_mfma_f32_16x16x32_bf16 v[68:71], v[148:151], v[116:119], v[68:71]
    v_dot2c_f32_bf16 v218, s33, v117
    v_dot2c_f32_bf16 v219, v117, v117
    ds_read_b64_tr_b16 v[132:133], v19 offset:11296
    ds_read_b64_tr_b16 v[134:135], v19 offset:12704
    s_waitcnt lgkmcnt(14)
    v_mfma_f32_16x16x32_bf16 v[72:75], v[152:155], v[112:115], v[72:75]
    v_mfma_f32_16x16x32_bf16 v[76:79], v[152:155], v[116:119], v[76:79]
    v_dot2c_f32_bf16 v218, s33, v118
    v_dot2c_f32_bf16 v219, v118, v118
    ds_read_b64_tr_b16 v[136:137], v19 offset:11328
    ds_read_b64_tr_b16 v[138:139], v19 offset:12736
    s_waitcnt lgkmcnt(14)
    v_mfma_f32_16x16x32_bf16 v[80:83], v[156:159], v[112:115], v[80:83]
    v_mfma_f32_16x16x32_bf16 v[84:87], v[156:159], v[116:119], v[84:87]
    v_dot2c_f32_bf16 v213, s33, v156
    v_dot2c_f32_bf16 v213, s33, v157
    v_dot2c_f32_bf16 v213, s33, v158
    v_dot2c_f32_bf16 v213, s33, v159
    v_dot2c_f32_bf16 v218, s33, v119
    v_dot2c_f32_bf16 v219, v119, v119
    ds_read_b64_tr_b16 v[140:141], v19 offset:11360
    ds_read_b64_tr_b16 v[142:143], v19 offset:12768
    s_waitcnt lgkmcnt(14)
    v_mfma_f32_16x16x32_bf16 v[88:91], v[160:163], v[112:115], v[88:91]
    v_mfma_f32_16x16x32_bf16 v[92:95], v[160:163], v[116:119], v[92:95]
    ds_read_b64_tr_b16 v[144:145], v19 offset:11392
    ds_read_b64_tr_b16 v[146:147], v19 offset:12800
    s_waitcnt lgkmcnt(14)
    v_mfma_f32_16x16x32_bf16 v[96:99], v[164:167], v[112:115], v[96:99]
    v_mfma_f32_16x16x32_bf16 v[100:103], v[164:167], v[116:119], v[100:103]
    ds_read_b64_tr_b16 v[148:149], v19 offset:11424
    ds_read_b64_tr_b16 v[150:151], v19 offset:12832
    s_waitcnt lgkmcnt(14)
    v_mfma_f32_16x16x32_bf16 v[104:107], v[168:171], v[112:115], v[104:107]
    v_mfma_f32_16x16x32_bf16 v[108:111], v[168:171], v[116:119], v[108:111]
    ds_read_b64_tr_b16 v[152:153], v19 offset:11456
    ds_read_b64_tr_b16 v[154:155], v19 offset:12864
    s_waitcnt lgkmcnt(12)
    v_mfma_f32_16x16x32_bf16 v[24:27], v[128:131], v[120:123], v[24:27]
    v_mfma_f32_16x16x32_bf16 v[28:31], v[128:131], v[124:127], v[28:31]
    v_dot2c_f32_bf16 v216, s33, v120
    v_dot2c_f32_bf16 v217, v120, v120
    ds_read_b64_tr_b16 v[156:157], v19 offset:11488
    ds_read_b64_tr_b16 v[158:159], v19 offset:12896
    s_waitcnt lgkmcnt(12)
    v_mfma_f32_16x16x32_bf16 v[32:35], v[132:135], v[120:123], v[32:35]
    v_mfma_f32_16x16x32_bf16 v[36:39], v[132:135], v[124:127], v[36:39]
    v_dot2c_f32_bf16 v216, s33, v121
    v_dot2c_f32_bf16 v217, v121, v121
    ds_read_b64_tr_b16 v[160:161], v19 offset:11520
    ds_read_b64_tr_b16 v[162:163], v19 offset:12928
    s_waitcnt lgkmcnt(12)
    v_mfma_f32_16x16x32_bf16 v[40:43], v[136:139], v[120:123], v[40:43]
    v_mfma_f32_16x16x32_bf16 v[44:47], v[136:139], v[124:127], v[44:47]
    v_dot2c_f32_bf16 v216, s33, v122
    v_dot2c_f32_bf16 v217, v122, v122
    ds_read_b64_tr_b16 v[164:165], v19 offset:11552
    ds_read_b64_tr_b16 v[166:167], v19 offset:12960
    s_waitcnt lgkmcnt(12)
    v_mfma_f32_16x16x32_bf16 v[48:51], v[140:143], v[120:123], v[48:51]
    v_mfma_f32_16x16x32_bf16 v[52:55], v[140:143], v[124:127], v[52:55]
    v_dot2c_f32_bf16 v212, s33, v140
    v_dot2c_f32_bf16 v212, s33, v141
    v_dot2c_f32_bf16 v212, s33, v142
    v_dot2c_f32_bf16 v212, s33, v143
    v_dot2c_f32_bf16 v216, s33, v123
    v_dot2c_f32_bf16 v217, v123, v123
    ds_read_b64_tr_b16 v[168:169], v19 offset:11584
    ds_read_b64_tr_b16 v[170:171], v19 offset:12992
    s_waitcnt lgkmcnt(12)
    v_mfma_f32_16x16x32_bf16 v[56:59], v[144:147], v[120:123], v[56:59]
    v_mfma_f32_16x16x32_bf16 v[60:63], v[144:147], v[124:127], v[60:63]
    v_dot2c_f32_bf16 v218, s33, v124
    v_dot2c_f32_bf16 v219, v124, v124
    s_barrier
    s_add_u32 s28, s28, 38912
    s_cmp_ge_u32 s28, 155648
    s_cselect_b32 s34, 155648, 0
    s_cselect_b32 s28, 0, s28
    s_sub_u32 s34, 38912, s34
    v_add_u32 v20, s34, v20
    v_add_u32 v21, s34, v21
    v_add_u32 v22, s34, v22
    v_add_u32 v23, s34, v23
    v_add_u32 v19, s34, v19
    ds_read_b128 v[112:115], v20
    ds_read_b128 v[116:119], v20 offset:2048
    ds_read_b64_tr_b16 v[128:129], v19 offset:0
    ds_read_b64_tr_b16 v[130:131], v19 offset:1408
    s_waitcnt lgkmcnt(14)
    v_mfma_f32_16x16x32_bf16 v[64:67], v[148:151], v[120:123], v[64:67]
    v_mfma_f32_16x16x32_bf16 v[68:71], v[148:151], v[124:127], v[68:71]
    v_dot2c_f32_bf16 v218, s33, v125
    v_dot2c_f32_bf16 v219, v125, v125
    ds_read_b64_tr_b16 v[132:133], v19 offset:32
    ds_read_b64_tr_b16 v[134:135], v19 offset:1440
    s_waitcnt lgkmcnt(14)
    v_mfma_f32_16x16x32_bf16 v[72:75], v[152:155], v[120:123], v[72:75]
    v_mfma_f32_16x16x32_bf16 v[76:79], v[152:155], v[124:127], v[76:79]
    v_dot2c_f32_bf16 v218, s33, v126
    v_dot2c_f32_bf16 v219, v126, v126
    ds_read_b64_tr_b16 v[136:137], v19 offset:64
    ds_read_b64_tr_b16 v[138:139], v19 offset:1472
    s_waitcnt lgkmcnt(14)
    v_mfma_f32_16x16x32_bf16 v[80:83], v[156:159], v[120:123], v[80:83]
    v_mfma_f32_16x16x32_bf16 v[84:87], v[156:159], v[124:127], v[84:87]
    v_dot2c_f32_bf16 v213, s33, v156
    v_dot2c_f32_bf16 v213, s33, v157
    v_dot2c_f32_bf16 v213, s33, v158
    v_dot2c_f32_bf16 v213, s33, v159
    v_dot2c_f32_bf16 v218, s33, v127
    v_dot2c_f32_bf16 v219, v127, v127
    ds_read_b64_tr_b16 v[140:141], v19 offset:96
    ds_read_b64_tr_b16 v[142:143], v19 offset:1504
    s_waitcnt lgkmcnt(14)
    v_mfma_f32_16x16x32_bf16 v[88:91], v[160:163], v[120:123], v[88:91]
    v_mfma_f32_16x16x32_bf16 v[92:95], v[160:163], v[124:127], v[92:95]
    ds_read_b64_tr_b16 v[144:145], v19 offset:128
    ds_read_b64_tr_b16 v[146:147], v19 offset:1536
    s_waitcnt lgkmcnt(14)
    v_mfma_f32_16x16x32_bf16 v[96:99], v[164:167], v[120:123], v[96:99]
    v_mfma_f32_16x16x32_bf16 v[100:103], v[164:167], v[124:127], v[100:103]
    ds_read_b64_tr_b16 v[148:149], v19 offset:160
    ds_read_b64_tr_b16 v[150:151], v19 offset:1568
    s_waitcnt lgkmcnt(14)
    v_mfma_f32_16x16x32_bf16 v[104:107], v[168:171], v[120:123], v[104:107]
    v_mfma_f32_16x16x32_bf16 v[108:111], v[168:171], v[124:127], v[108:111]
    s_add_u32 s32, s32, 1
    s_cmp_lt_u32 s32, 8
    s_cbranch_scc1 g1_loop_0_3
g1_post_0:
    s_waitcnt lgkmcnt(0)
    s_nop 3
    v_xor_b32 v8, 16, v2
    v_lshlrev_b32 v8, 2, v8
    v_xor_b32 v9, 32, v2
    v_lshlrev_b32 v9, 2, v9
    ds_bpermute_b32 v220, v8, v216
    ds_bpermute_b32 v221, v8, v217
    ds_bpermute_b32 v222, v8, v218
    ds_bpermute_b32 v223, v8, v219
    s_waitcnt lgkmcnt(0)
    v_add_f32 v216, v216, v220
    v_add_f32 v217, v217, v221
    v_add_f32 v218, v218, v222
    v_add_f32 v219, v219, v223
    ds_bpermute_b32 v220, v9, v216
    ds_bpermute_b32 v221, v9, v217
    ds_bpermute_b32 v222, v9, v218
    ds_bpermute_b32 v223, v9, v219
    s_waitcnt lgkmcnt(0)
    v_add_f32 v216, v216, v220
    v_add_f32 v217, v217, v221
    v_add_f32 v218, v218, v222
    v_add_f32 v219, v219, v223
    v_mul_f32 v216, 0x3b000000, v216
    v_mul_f32 v217, 0x3b000000, v217
    v_fma_f32 v217, -v216, v216, v217
    v_max_f32 v217, 0, v217
    v_cvt_pk_bf16_f32 v220, v216, v217
    v_lshlrev_b32 v216, 16, v220
    v_and_b32 v217, 0xffff0000, v220
    v_add_f32 v217, 0x3727c5ac, v217
    v_cvt_pk_bf16_f32 v220, v217, v217
    v_lshlrev_b32 v217, 16, v220
    v_sqrt_f32 v217, v217
    s_nop 1
    v_cvt_pk_bf16_f32 v220, v217, v217
    v_lshlrev_b32 v217, 16, v220
    v_rcp_f32 v217, v217
    s_nop 1
    v_mul_f32 v218, 0x3b000000, v218
    v_mul_f32 v219, 0x3b000000, v219
    v_fma_f32 v219, -v218, v218, v219
    v_max_f32 v219, 0, v219
    v_cvt_pk_bf16_f32 v220, v218, v219
    v_lshlrev_b32 v218, 16, v220
    v_and_b32 v219, 0xffff0000, v220
    v_add_f32 v219, 0x3727c5ac, v219
    v_cvt_pk_bf16_f32 v220, v219, v219
    v_lshlrev_b32 v219, 16, v220
    v_sqrt_f32 v219, v219
    s_nop 1
    v_cvt_pk_bf16_f32 v220, v219, v219
    v_lshlrev_b32 v219, 16, v220
    v_rcp_f32 v219, v219
    s_nop 1
    s_lshl_b32 s22, s18, 8
    s_add_u32 s22, s22, 155648
    v_lshlrev_b32 v8, 3, v5
    v_add_u32 v8, s22, v8
    ds_write_b64 v8, v[216:217]
    ds_write_b64 v8, v[218:219] offset:128
    s_nop 3
    s_lshl_b32 s34, s18, 6
    s_add_u32 s34, s34, 156672
    v_lshlrev_b32 v8, 2, v5
    v_add_u32 v8, s34, v8
    ds_add_f32 v8, v212
    ds_add_f32 v8, v213 offset:256
    s_cmp_eq_u32 s18, 3
    s_cbranch_scc1 g1_ws3_0
    ds_add_f32 v8, v214 offset:512
g1_ws3_0:
    s_waitcnt lgkmcnt(0)
    v_mov_b32 v8, 157440
    v_mov_b32 v9, 1
    s_mov_b64 s[34:35], exec
    s_mov_b64 exec, 1
    ds_add_u32 v8, v9
    s_mov_b64 exec, s[34:35]
    s_add_u32 s8, s6, 0x700000
    s_addc_u32 s9, s7, 0
    s_and_b32 s9, s9, 0xffff
    s_mov_b32 s10, 0x400000
    s_mov_b32 s11, 0x20000
    s_add_u32 s12, s6, 0xb00000
    s_addc_u32 s13, s7, 0
    s_and_b32 s13, s13, 0xffff
    s_mov_b32 s14, 0x800000
    s_mov_b32 s15, 0x20000
    s_mov_b32 s36, s4
    s_mov_b32 s37, s5
    s_and_b32 s37, s37, 0xffff
    s_mov_b32 s38, 0xe00
    s_mov_b32 s39, 0x20000
    s_lshl_b32 s20, s16, 7
    s_lshl_b32 s21, s18, 5
    s_add_u32 s20, s20, s21
    s_mul_i32 s21, s17, 176
    s_lshl_b32 s22, s18, 5
    v_add_u32 v11, s22, v5
    v_mul_u32_u24 v11, 368, v11
    v_lshl_add_u32 v11, v6, 3, v11
    v_add_u32 v11, 0x10000, v11
    s_sub_u32 s22, s21, 1024
    s_lshl_b32 s22, s22, 1
    v_lshlrev_b32 v12, 3, v6
    v_add_u32 v12, s22, v12
    buffer_load_dwordx2 v[112:113], v12, s[36:39], 0 offen offset:0
    buffer_load_dwordx2 v[114:115], v12, s[36:39], 0 offen offset:32
    buffer_load_dwordx2 v[116:117], v12, s[36:39], 0 offen offset:64
    buffer_load_dwordx2 v[118:119], v12, s[36:39], 0 offen offset:96
    buffer_load_dwordx2 v[120:121], v12, s[36:39], 0 offen offset:128
    buffer_load_dwordx2 v[122:123], v12, s[36:39], 0 offen offset:160
    buffer_load_dwordx2 v[124:125], v12, s[36:39], 0 offen offset:192
    buffer_load_dwordx2 v[126:127], v12, s[36:39], 0 offen offset:224
    buffer_load_dwordx2 v[128:129], v12, s[36:39], 0 offen offset:256
    buffer_load_dwordx2 v[130:131], v12, s[36:39], 0 offen offset:288
    buffer_load_dwordx2 v[132:133], v12, s[36:39], 0 offen offset:320
    s_lshl_b32 s22, s18, 8
    s_add_u32 s22, s22, 155648
    v_lshlrev_b32 v13, 3, v5
    v_add_u32 v13, s22, v13
    v_mov_b32 v8, 157440
g1_poll_0:
    ds_read_b32 v9, v8
    s_waitcnt lgkmcnt(0)
    v_readfirstlane_b32 s22, v9
    s_nop 1
    s_cmp_lt_u32 s22, 4
    s_cbranch_scc1 g1_poll_0
    ds_read_b64 v[168:169], v13 offset:0
    ds_read_b64 v[184:185], v13 offset:128
    v_lshlrev_b32 v8, 2, v5
    v_add_u32 v8, 156672, v8
    v_lshlrev_b32 v9, 4, v6
    v_add_u32 v9, 156672, v9
    s_waitcnt lgkmcnt(0)
    s_waitcnt vmcnt(0)
    ds_read_b128 v[208:211], v9 offset:0
    v_lshlrev_b32 v140, 16, v112
    v_and_b32 v141, 0xffff0000, v112
    v_lshlrev_b32 v142, 16, v113
    v_and_b32 v143, 0xffff0000, v113
    s_waitcnt lgkmcnt(0)
    v_fma_f32 v24, -v168, v208, v24
    v_fma_f32 v24, v169, v24, v140
    v_max_f32 v24, 0, v24
    v_mul_f32 v24, v24, v24
    v_fma_f32 v25, -v168, v209, v25
    v_fma_f32 v25, v169, v25, v141
    v_max_f32 v25, 0, v25
    v_mul_f32 v25, v25, v25
    v_fma_f32 v26, -v168, v210, v26
    v_fma_f32 v26, v169, v26, v142
    v_max_f32 v26, 0, v26
    v_mul_f32 v26, v26, v26
    v_fma_f32 v27, -v168, v211, v27
    v_fma_f32 v27, v169, v27, v143
    v_max_f32 v27, 0, v27
    v_mul_f32 v27, v27, v27
    v_cvt_pk_bf16_f32 v24, v24, v25
    v_cvt_pk_bf16_f32 v25, v26, v27
    ds_write_b64 v11, v[24:25] offset:0
    v_fma_f32 v28, -v184, v208, v28
    v_fma_f32 v28, v185, v28, v140
    v_max_f32 v28, 0, v28
    v_mul_f32 v28, v28, v28
    v_fma_f32 v29, -v184, v209, v29
    v_fma_f32 v29, v185, v29, v141
    v_max_f32 v29, 0, v29
    v_mul_f32 v29, v29, v29
    v_fma_f32 v30, -v184, v210, v30
    v_fma_f32 v30, v185, v30, v142
    v_max_f32 v30, 0, v30
    v_mul_f32 v30, v30, v30
    v_fma_f32 v31, -v184, v211, v31
    v_fma_f32 v31, v185, v31, v143
    v_max_f32 v31, 0, v31
    v_mul_f32 v31, v31, v31
    v_cvt_pk_bf16_f32 v28, v28, v29
    v_cvt_pk_bf16_f32 v29, v30, v31
    ds_write_b64 v11, v[28:29] offset:5888
    ds_read_b128 v[208:211], v9 offset:64
    v_lshlrev_b32 v140, 16, v114
    v_and_b32 v141, 0xffff0000, v114
    v_lshlrev_b32 v142, 16, v115
    v_and_b32 v143, 0xffff0000, v115
    s_waitcnt lgkmcnt(0)
    v_fma_f32 v32, -v168, v208, v32
    v_fma_f32 v32, v169, v32, v140
    v_max_f32 v32, 0, v32
    v_mul_f32 v32, v32, v32
    v_fma_f32 v33, -v168, v209, v33
    v_fma_f32 v33, v169, v33, v141
    v_max_f32 v33, 0, v33
    v_mul_f32 v33, v33, v33
    v_fma_f32 v34, -v168, v210, v34
    v_fma_f32 v34, v169, v34, v142
    v_max_f32 v34, 0, v34
    v_mul_f32 v34, v34, v34
    v_fma_f32 v35, -v168, v211, v35
    v_fma_f32 v35, v169, v35, v143
    v_max_f32 v35, 0, v35
    v_mul_f32 v35, v35, v35
    v_cvt_pk_bf16_f32 v32, v32, v33
    v_cvt_pk_bf16_f32 v33, v34, v35
    ds_write_b64 v11, v[32:33] offset:32
    v_fma_f32 v36, -v184, v208, v36
    v_fma_f32 v36, v185, v36, v140
    v_max_f32 v36, 0, v36
    v_mul_f32 v36, v36, v36
    v_fma_f32 v37, -v184, v209, v37
    v_fma_f32 v37, v185, v37, v141
    v_max_f32 v37, 0, v37
    v_mul_f32 v37, v37, v37
    v_fma_f32 v38, -v184, v210, v38
    v_fma_f32 v38, v185, v38, v142
    v_max_f32 v38, 0, v38
    v_mul_f32 v38, v38, v38
    v_fma_f32 v39, -v184, v211, v39
    v_fma_f32 v39, v185, v39, v143
    v_max_f32 v39, 0, v39
    v_mul_f32 v39, v39, v39
    v_cvt_pk_bf16_f32 v36, v36, v37
    v_cvt_pk_bf16_f32 v37, v38, v39
    ds_write_b64 v11, v[36:37] offset:5920
    ds_read_b128 v[208:211], v9 offset:128
    v_lshlrev_b32 v140, 16, v116
    v_and_b32 v141, 0xffff0000, v116
    v_lshlrev_b32 v142, 16, v117
    v_and_b32 v143, 0xffff0000, v117
    s_waitcnt lgkmcnt(0)
    v_fma_f32 v40, -v168, v208, v40
    v_fma_f32 v40, v169, v40, v140
    v_max_f32 v40, 0, v40
    v_mul_f32 v40, v40, v40
    v_fma_f32 v41, -v168, v209, v41
    v_fma_f32 v41, v169, v41, v141
    v_max_f32 v41, 0, v41
    v_mul_f32 v41, v41, v41
    v_fma_f32 v42, -v168, v210, v42
    v_fma_f32 v42, v169, v42, v142
    v_max_f32 v42, 0, v42
    v_mul_f32 v42, v42, v42
    v_fma_f32 v43, -v168, v211, v43
    v_fma_f32 v43, v169, v43, v143
    v_max_f32 v43, 0, v43
    v_mul_f32 v43, v43, v43
    v_cvt_pk_bf16_f32 v40, v40, v41
    v_cvt_pk_bf16_f32 v41, v42, v43
    ds_write_b64 v11, v[40:41] offset:64
    v_fma_f32 v44, -v184, v208, v44
    v_fma_f32 v44, v185, v44, v140
    v_max_f32 v44, 0, v44
    v_mul_f32 v44, v44, v44
    v_fma_f32 v45, -v184, v209, v45
    v_fma_f32 v45, v185, v45, v141
    v_max_f32 v45, 0, v45
    v_mul_f32 v45, v45, v45
    v_fma_f32 v46, -v184, v210, v46
    v_fma_f32 v46, v185, v46, v142
    v_max_f32 v46, 0, v46
    v_mul_f32 v46, v46, v46
    v_fma_f32 v47, -v184, v211, v47
    v_fma_f32 v47, v185, v47, v143
    v_max_f32 v47, 0, v47
    v_mul_f32 v47, v47, v47
    v_cvt_pk_bf16_f32 v44, v44, v45
    v_cvt_pk_bf16_f32 v45, v46, v47
    ds_write_b64 v11, v[44:45] offset:5952
    ds_read_b128 v[208:211], v9 offset:192
    v_lshlrev_b32 v140, 16, v118
    v_and_b32 v141, 0xffff0000, v118
    v_lshlrev_b32 v142, 16, v119
    v_and_b32 v143, 0xffff0000, v119
    s_waitcnt lgkmcnt(0)
    v_fma_f32 v48, -v168, v208, v48
    v_fma_f32 v48, v169, v48, v140
    v_max_f32 v48, 0, v48
    v_mul_f32 v48, v48, v48
    v_fma_f32 v49, -v168, v209, v49
    v_fma_f32 v49, v169, v49, v141
    v_max_f32 v49, 0, v49
    v_mul_f32 v49, v49, v49
    v_fma_f32 v50, -v168, v210, v50
    v_fma_f32 v50, v169, v50, v142
    v_max_f32 v50, 0, v50
    v_mul_f32 v50, v50, v50
    v_fma_f32 v51, -v168, v211, v51
    v_fma_f32 v51, v169, v51, v143
    v_max_f32 v51, 0, v51
    v_mul_f32 v51, v51, v51
    v_cvt_pk_bf16_f32 v48, v48, v49
    v_cvt_pk_bf16_f32 v49, v50, v51
    ds_write_b64 v11, v[48:49] offset:96
    v_fma_f32 v52, -v184, v208, v52
    v_fma_f32 v52, v185, v52, v140
    v_max_f32 v52, 0, v52
    v_mul_f32 v52, v52, v52
    v_fma_f32 v53, -v184, v209, v53
    v_fma_f32 v53, v185, v53, v141
    v_max_f32 v53, 0, v53
    v_mul_f32 v53, v53, v53
    v_fma_f32 v54, -v184, v210, v54
    v_fma_f32 v54, v185, v54, v142
    v_max_f32 v54, 0, v54
    v_mul_f32 v54, v54, v54
    v_fma_f32 v55, -v184, v211, v55
    v_fma_f32 v55, v185, v55, v143
    v_max_f32 v55, 0, v55
    v_mul_f32 v55, v55, v55
    v_cvt_pk_bf16_f32 v52, v52, v53
    v_cvt_pk_bf16_f32 v53, v54, v55
    ds_write_b64 v11, v[52:53] offset:5984
    ds_read_b128 v[208:211], v9 offset:256
    v_lshlrev_b32 v140, 16, v120
    v_and_b32 v141, 0xffff0000, v120
    v_lshlrev_b32 v142, 16, v121
    v_and_b32 v143, 0xffff0000, v121
    s_waitcnt lgkmcnt(0)
    v_fma_f32 v56, -v168, v208, v56
    v_fma_f32 v56, v169, v56, v140
    v_max_f32 v56, 0, v56
    v_mul_f32 v56, v56, v56
    v_fma_f32 v57, -v168, v209, v57
    v_fma_f32 v57, v169, v57, v141
    v_max_f32 v57, 0, v57
    v_mul_f32 v57, v57, v57
    v_fma_f32 v58, -v168, v210, v58
    v_fma_f32 v58, v169, v58, v142
    v_max_f32 v58, 0, v58
    v_mul_f32 v58, v58, v58
    v_fma_f32 v59, -v168, v211, v59
    v_fma_f32 v59, v169, v59, v143
    v_max_f32 v59, 0, v59
    v_mul_f32 v59, v59, v59
    v_cvt_pk_bf16_f32 v56, v56, v57
    v_cvt_pk_bf16_f32 v57, v58, v59
    ds_write_b64 v11, v[56:57] offset:128
    v_fma_f32 v60, -v184, v208, v60
    v_fma_f32 v60, v185, v60, v140
    v_max_f32 v60, 0, v60
    v_mul_f32 v60, v60, v60
    v_fma_f32 v61, -v184, v209, v61
    v_fma_f32 v61, v185, v61, v141
    v_max_f32 v61, 0, v61
    v_mul_f32 v61, v61, v61
    v_fma_f32 v62, -v184, v210, v62
    v_fma_f32 v62, v185, v62, v142
    v_max_f32 v62, 0, v62
    v_mul_f32 v62, v62, v62
    v_fma_f32 v63, -v184, v211, v63
    v_fma_f32 v63, v185, v63, v143
    v_max_f32 v63, 0, v63
    v_mul_f32 v63, v63, v63
    v_cvt_pk_bf16_f32 v60, v60, v61
    v_cvt_pk_bf16_f32 v61, v62, v63
    ds_write_b64 v11, v[60:61] offset:6016
    ds_read_b128 v[208:211], v9 offset:320
    v_lshlrev_b32 v140, 16, v122
    v_and_b32 v141, 0xffff0000, v122
    v_lshlrev_b32 v142, 16, v123
    v_and_b32 v143, 0xffff0000, v123
    s_waitcnt lgkmcnt(0)
    v_fma_f32 v64, -v168, v208, v64
    v_fma_f32 v64, v169, v64, v140
    v_max_f32 v64, 0, v64
    v_mul_f32 v64, v64, v64
    v_fma_f32 v65, -v168, v209, v65
    v_fma_f32 v65, v169, v65, v141
    v_max_f32 v65, 0, v65
    v_mul_f32 v65, v65, v65
    v_fma_f32 v66, -v168, v210, v66
    v_fma_f32 v66, v169, v66, v142
    v_max_f32 v66, 0, v66
    v_mul_f32 v66, v66, v66
    v_fma_f32 v67, -v168, v211, v67
    v_fma_f32 v67, v169, v67, v143
    v_max_f32 v67, 0, v67
    v_mul_f32 v67, v67, v67
    v_cvt_pk_bf16_f32 v64, v64, v65
    v_cvt_pk_bf16_f32 v65, v66, v67
    ds_write_b64 v11, v[64:65] offset:160
    v_fma_f32 v68, -v184, v208, v68
    v_fma_f32 v68, v185, v68, v140
    v_max_f32 v68, 0, v68
    v_mul_f32 v68, v68, v68
    v_fma_f32 v69, -v184, v209, v69
    v_fma_f32 v69, v185, v69, v141
    v_max_f32 v69, 0, v69
    v_mul_f32 v69, v69, v69
    v_fma_f32 v70, -v184, v210, v70
    v_fma_f32 v70, v185, v70, v142
    v_max_f32 v70, 0, v70
    v_mul_f32 v70, v70, v70
    v_fma_f32 v71, -v184, v211, v71
    v_fma_f32 v71, v185, v71, v143
    v_max_f32 v71, 0, v71
    v_mul_f32 v71, v71, v71
    v_cvt_pk_bf16_f32 v68, v68, v69
    v_cvt_pk_bf16_f32 v69, v70, v71
    ds_write_b64 v11, v[68:69] offset:6048
    ds_read_b128 v[208:211], v9 offset:384
    v_lshlrev_b32 v140, 16, v124
    v_and_b32 v141, 0xffff0000, v124
    v_lshlrev_b32 v142, 16, v125
    v_and_b32 v143, 0xffff0000, v125
    s_waitcnt lgkmcnt(0)
    v_fma_f32 v72, -v168, v208, v72
    v_fma_f32 v72, v169, v72, v140
    v_max_f32 v72, 0, v72
    v_mul_f32 v72, v72, v72
    v_fma_f32 v73, -v168, v209, v73
    v_fma_f32 v73, v169, v73, v141
    v_max_f32 v73, 0, v73
    v_mul_f32 v73, v73, v73
    v_fma_f32 v74, -v168, v210, v74
    v_fma_f32 v74, v169, v74, v142
    v_max_f32 v74, 0, v74
    v_mul_f32 v74, v74, v74
    v_fma_f32 v75, -v168, v211, v75
    v_fma_f32 v75, v169, v75, v143
    v_max_f32 v75, 0, v75
    v_mul_f32 v75, v75, v75
    v_cvt_pk_bf16_f32 v72, v72, v73
    v_cvt_pk_bf16_f32 v73, v74, v75
    ds_write_b64 v11, v[72:73] offset:192
    v_fma_f32 v76, -v184, v208, v76
    v_fma_f32 v76, v185, v76, v140
    v_max_f32 v76, 0, v76
    v_mul_f32 v76, v76, v76
    v_fma_f32 v77, -v184, v209, v77
    v_fma_f32 v77, v185, v77, v141
    v_max_f32 v77, 0, v77
    v_mul_f32 v77, v77, v77
    v_fma_f32 v78, -v184, v210, v78
    v_fma_f32 v78, v185, v78, v142
    v_max_f32 v78, 0, v78
    v_mul_f32 v78, v78, v78
    v_fma_f32 v79, -v184, v211, v79
    v_fma_f32 v79, v185, v79, v143
    v_max_f32 v79, 0, v79
    v_mul_f32 v79, v79, v79
    v_cvt_pk_bf16_f32 v76, v76, v77
    v_cvt_pk_bf16_f32 v77, v78, v79
    ds_write_b64 v11, v[76:77] offset:6080
    ds_read_b128 v[208:211], v9 offset:448
    v_lshlrev_b32 v140, 16, v126
    v_and_b32 v141, 0xffff0000, v126
    v_lshlrev_b32 v142, 16, v127
    v_and_b32 v143, 0xffff0000, v127
    s_waitcnt lgkmcnt(0)
    v_fma_f32 v80, -v168, v208, v80
    v_fma_f32 v80, v169, v80, v140
    v_max_f32 v80, 0, v80
    v_mul_f32 v80, v80, v80
    v_fma_f32 v81, -v168, v209, v81
    v_fma_f32 v81, v169, v81, v141
    v_max_f32 v81, 0, v81
    v_mul_f32 v81, v81, v81
    v_fma_f32 v82, -v168, v210, v82
    v_fma_f32 v82, v169, v82, v142
    v_max_f32 v82, 0, v82
    v_mul_f32 v82, v82, v82
    v_fma_f32 v83, -v168, v211, v83
    v_fma_f32 v83, v169, v83, v143
    v_max_f32 v83, 0, v83
    v_mul_f32 v83, v83, v83
    v_cvt_pk_bf16_f32 v80, v80, v81
    v_cvt_pk_bf16_f32 v81, v82, v83
    ds_write_b64 v11, v[80:81] offset:224
    v_fma_f32 v84, -v184, v208, v84
    v_fma_f32 v84, v185, v84, v140
    v_max_f32 v84, 0, v84
    v_mul_f32 v84, v84, v84
    v_fma_f32 v85, -v184, v209, v85
    v_fma_f32 v85, v185, v85, v141
    v_max_f32 v85, 0, v85
    v_mul_f32 v85, v85, v85
    v_fma_f32 v86, -v184, v210, v86
    v_fma_f32 v86, v185, v86, v142
    v_max_f32 v86, 0, v86
    v_mul_f32 v86, v86, v86
    v_fma_f32 v87, -v184, v211, v87
    v_fma_f32 v87, v185, v87, v143
    v_max_f32 v87, 0, v87
    v_mul_f32 v87, v87, v87
    v_cvt_pk_bf16_f32 v84, v84, v85
    v_cvt_pk_bf16_f32 v85, v86, v87
    ds_write_b64 v11, v[84:85] offset:6112
    ds_read_b128 v[208:211], v9 offset:512
    v_lshlrev_b32 v140, 16, v128
    v_and_b32 v141, 0xffff0000, v128
    v_lshlrev_b32 v142, 16, v129
    v_and_b32 v143, 0xffff0000, v129
    s_waitcnt lgkmcnt(0)
    v_fma_f32 v88, -v168, v208, v88
    v_fma_f32 v88, v169, v88, v140
    v_max_f32 v88, 0, v88
    v_mul_f32 v88, v88, v88
    v_fma_f32 v89, -v168, v209, v89
    v_fma_f32 v89, v169, v89, v141
    v_max_f32 v89, 0, v89
    v_mul_f32 v89, v89, v89
    v_fma_f32 v90, -v168, v210, v90
    v_fma_f32 v90, v169, v90, v142
    v_max_f32 v90, 0, v90
    v_mul_f32 v90, v90, v90
    v_fma_f32 v91, -v168, v211, v91
    v_fma_f32 v91, v169, v91, v143
    v_max_f32 v91, 0, v91
    v_mul_f32 v91, v91, v91
    v_cvt_pk_bf16_f32 v88, v88, v89
    v_cvt_pk_bf16_f32 v89, v90, v91
    ds_write_b64 v11, v[88:89] offset:256
    v_fma_f32 v92, -v184, v208, v92
    v_fma_f32 v92, v185, v92, v140
    v_max_f32 v92, 0, v92
    v_mul_f32 v92, v92, v92
    v_fma_f32 v93, -v184, v209, v93
    v_fma_f32 v93, v185, v93, v141
    v_max_f32 v93, 0, v93
    v_mul_f32 v93, v93, v93
    v_fma_f32 v94, -v184, v210, v94
    v_fma_f32 v94, v185, v94, v142
    v_max_f32 v94, 0, v94
    v_mul_f32 v94, v94, v94
    v_fma_f32 v95, -v184, v211, v95
    v_fma_f32 v95, v185, v95, v143
    v_max_f32 v95, 0, v95
    v_mul_f32 v95, v95, v95
    v_cvt_pk_bf16_f32 v92, v92, v93
    v_cvt_pk_bf16_f32 v93, v94, v95
    ds_write_b64 v11, v[92:93] offset:6144
    ds_read_b128 v[208:211], v9 offset:576
    v_lshlrev_b32 v140, 16, v130
    v_and_b32 v141, 0xffff0000, v130
    v_lshlrev_b32 v142, 16, v131
    v_and_b32 v143, 0xffff0000, v131
    s_waitcnt lgkmcnt(0)
    v_fma_f32 v96, -v168, v208, v96
    v_fma_f32 v96, v169, v96, v140
    v_max_f32 v96, 0, v96
    v_mul_f32 v96, v96, v96
    v_fma_f32 v97, -v168, v209, v97
    v_fma_f32 v97, v169, v97, v141
    v_max_f32 v97, 0, v97
    v_mul_f32 v97, v97, v97
    v_fma_f32 v98, -v168, v210, v98
    v_fma_f32 v98, v169, v98, v142
    v_max_f32 v98, 0, v98
    v_mul_f32 v98, v98, v98
    v_fma_f32 v99, -v168, v211, v99
    v_fma_f32 v99, v169, v99, v143
    v_max_f32 v99, 0, v99
    v_mul_f32 v99, v99, v99
    v_cvt_pk_bf16_f32 v96, v96, v97
    v_cvt_pk_bf16_f32 v97, v98, v99
    ds_write_b64 v11, v[96:97] offset:288
    v_fma_f32 v100, -v184, v208, v100
    v_fma_f32 v100, v185, v100, v140
    v_max_f32 v100, 0, v100
    v_mul_f32 v100, v100, v100
    v_fma_f32 v101, -v184, v209, v101
    v_fma_f32 v101, v185, v101, v141
    v_max_f32 v101, 0, v101
    v_mul_f32 v101, v101, v101
    v_fma_f32 v102, -v184, v210, v102
    v_fma_f32 v102, v185, v102, v142
    v_max_f32 v102, 0, v102
    v_mul_f32 v102, v102, v102
    v_fma_f32 v103, -v184, v211, v103
    v_fma_f32 v103, v185, v103, v143
    v_max_f32 v103, 0, v103
    v_mul_f32 v103, v103, v103
    v_cvt_pk_bf16_f32 v100, v100, v101
    v_cvt_pk_bf16_f32 v101, v102, v103
    ds_write_b64 v11, v[100:101] offset:6176
    ds_read_b128 v[208:211], v9 offset:640
    v_lshlrev_b32 v140, 16, v132
    v_and_b32 v141, 0xffff0000, v132
    v_lshlrev_b32 v142, 16, v133
    v_and_b32 v143, 0xffff0000, v133
    s_waitcnt lgkmcnt(0)
    v_fma_f32 v104, -v168, v208, v104
    v_fma_f32 v104, v169, v104, v140
    v_max_f32 v104, 0, v104
    v_mul_f32 v104, v104, v104
    v_fma_f32 v105, -v168, v209, v105
    v_fma_f32 v105, v169, v105, v141
    v_max_f32 v105, 0, v105
    v_mul_f32 v105, v105, v105
    v_fma_f32 v106, -v168, v210, v106
    v_fma_f32 v106, v169, v106, v142
    v_max_f32 v106, 0, v106
    v_mul_f32 v106, v106, v106
    v_fma_f32 v107, -v168, v211, v107
    v_fma_f32 v107, v169, v107, v143
    v_max_f32 v107, 0, v107
    v_mul_f32 v107, v107, v107
    v_cvt_pk_bf16_f32 v104, v104, v105
    v_cvt_pk_bf16_f32 v105, v106, v107
    ds_write_b64 v11, v[104:105] offset:320
    v_fma_f32 v108, -v184, v208, v108
    v_fma_f32 v108, v185, v108, v140
    v_max_f32 v108, 0, v108
    v_mul_f32 v108, v108, v108
    v_fma_f32 v109, -v184, v209, v109
    v_fma_f32 v109, v185, v109, v141
    v_max_f32 v109, 0, v109
    v_mul_f32 v109, v109, v109
    v_fma_f32 v110, -v184, v210, v110
    v_fma_f32 v110, v185, v110, v142
    v_max_f32 v110, 0, v110
    v_mul_f32 v110, v110, v110
    v_fma_f32 v111, -v184, v211, v111
    v_fma_f32 v111, v185, v111, v143
    v_max_f32 v111, 0, v111
    v_mul_f32 v111, v111, v111
    v_cvt_pk_bf16_f32 v108, v108, v109
    v_cvt_pk_bf16_f32 v109, v110, v111
    ds_write_b64 v11, v[108:109] offset:6208
    s_waitcnt lgkmcnt(0)
    s_sub_u32 s22, s21, 1024
    s_lshl_b32 s22, s22, 1
    v_add_u32 v8, 0, v2
    v_mul_u32_u24 v10, 2979, v8
    v_lshrrev_b32 v10, 16, v10
    v_mul_u32_u24 v12, 22, v10
    v_sub_u32 v12, v8, v12
    s_lshl_b32 s23, s18, 5
    v_add_u32 v10, s23, v10
    v_mul_u32_u24 v13, 368, v10
    v_lshl_add_u32 v13, v12, 4, v13
    v_add_u32 v13, 0x10000, v13
    ds_read_b128 v[24:27], v13
    s_lshl_b32 s23, s16, 7
    v_add_u32 v10, s23, v10
    v_lshlrev_b32 v10, 12, v10
    v_lshl_add_u32 v10, v12, 4, v10
    v_add_u32 v112, s22, v10
    v_add_u32 v8, 64, v2
    v_mul_u32_u24 v10, 2979, v8
    v_lshrrev_b32 v10, 16, v10
    v_mul_u32_u24 v12, 22, v10
    v_sub_u32 v12, v8, v12
    s_lshl_b32 s23, s18, 5
    v_add_u32 v10, s23, v10
    v_mul_u32_u24 v13, 368, v10
    v_lshl_add_u32 v13, v12, 4, v13
    v_add_u32 v13, 0x10000, v13
    ds_read_b128 v[28:31], v13
    s_lshl_b32 s23, s16, 7
    v_add_u32 v10, s23, v10
    v_lshlrev_b32 v10, 12, v10
    v_lshl_add_u32 v10, v12, 4, v10
    v_add_u32 v113, s22, v10
    v_add_u32 v8, 128, v2
    v_mul_u32_u24 v10, 2979, v8
    v_lshrrev_b32 v10, 16, v10
    v_mul_u32_u24 v12, 22, v10
    v_sub_u32 v12, v8, v12
    s_lshl_b32 s23, s18, 5
    v_add_u32 v10, s23, v10
    v_mul_u32_u24 v13, 368, v10
    v_lshl_add_u32 v13, v12, 4, v13
    v_add_u32 v13, 0x10000, v13
    ds_read_b128 v[32:35], v13
    s_lshl_b32 s23, s16, 7
    v_add_u32 v10, s23, v10
    v_lshlrev_b32 v10, 12, v10
    v_lshl_add_u32 v10, v12, 4, v10
    v_add_u32 v114, s22, v10
    v_add_u32 v8, 192, v2
    v_mul_u32_u24 v10, 2979, v8
    v_lshrrev_b32 v10, 16, v10
    v_mul_u32_u24 v12, 22, v10
    v_sub_u32 v12, v8, v12
    s_lshl_b32 s23, s18, 5
    v_add_u32 v10, s23, v10
    v_mul_u32_u24 v13, 368, v10
    v_lshl_add_u32 v13, v12, 4, v13
    v_add_u32 v13, 0x10000, v13
    ds_read_b128 v[36:39], v13
    s_lshl_b32 s23, s16, 7
    v_add_u32 v10, s23, v10
    v_lshlrev_b32 v10, 12, v10
    v_lshl_add_u32 v10, v12, 4, v10
    v_add_u32 v115, s22, v10
    v_add_u32 v8, 256, v2
    v_mul_u32_u24 v10, 2979, v8
    v_lshrrev_b32 v10, 16, v10
    v_mul_u32_u24 v12, 22, v10
    v_sub_u32 v12, v8, v12
    s_lshl_b32 s23, s18, 5
    v_add_u32 v10, s23, v10
    v_mul_u32_u24 v13, 368, v10
    v_lshl_add_u32 v13, v12, 4, v13
    v_add_u32 v13, 0x10000, v13
    ds_read_b128 v[40:43], v13
    s_lshl_b32 s23, s16, 7
    v_add_u32 v10, s23, v10
    v_lshlrev_b32 v10, 12, v10
    v_lshl_add_u32 v10, v12, 4, v10
    v_add_u32 v116, s22, v10
    v_add_u32 v8, 320, v2
    v_mul_u32_u24 v10, 2979, v8
    v_lshrrev_b32 v10, 16, v10
    v_mul_u32_u24 v12, 22, v10
    v_sub_u32 v12, v8, v12
    s_lshl_b32 s23, s18, 5
    v_add_u32 v10, s23, v10
    v_mul_u32_u24 v13, 368, v10
    v_lshl_add_u32 v13, v12, 4, v13
    v_add_u32 v13, 0x10000, v13
    ds_read_b128 v[44:47], v13
    s_lshl_b32 s23, s16, 7
    v_add_u32 v10, s23, v10
    v_lshlrev_b32 v10, 12, v10
    v_lshl_add_u32 v10, v12, 4, v10
    v_add_u32 v117, s22, v10
    v_add_u32 v8, 384, v2
    v_mul_u32_u24 v10, 2979, v8
    v_lshrrev_b32 v10, 16, v10
    v_mul_u32_u24 v12, 22, v10
    v_sub_u32 v12, v8, v12
    s_lshl_b32 s23, s18, 5
    v_add_u32 v10, s23, v10
    v_mul_u32_u24 v13, 368, v10
    v_lshl_add_u32 v13, v12, 4, v13
    v_add_u32 v13, 0x10000, v13
    ds_read_b128 v[48:51], v13
    s_lshl_b32 s23, s16, 7
    v_add_u32 v10, s23, v10
    v_lshlrev_b32 v10, 12, v10
    v_lshl_add_u32 v10, v12, 4, v10
    v_add_u32 v118, s22, v10
    v_add_u32 v8, 448, v2
    v_mul_u32_u24 v10, 2979, v8
    v_lshrrev_b32 v10, 16, v10
    v_mul_u32_u24 v12, 22, v10
    v_sub_u32 v12, v8, v12
    s_lshl_b32 s23, s18, 5
    v_add_u32 v10, s23, v10
    v_mul_u32_u24 v13, 368, v10
    v_lshl_add_u32 v13, v12, 4, v13
    v_add_u32 v13, 0x10000, v13
    ds_read_b128 v[52:55], v13
    s_lshl_b32 s23, s16, 7
    v_add_u32 v10, s23, v10
    v_lshlrev_b32 v10, 12, v10
    v_lshl_add_u32 v10, v12, 4, v10
    v_add_u32 v119, s22, v10
    v_add_u32 v8, 512, v2
    v_mul_u32_u24 v10, 2979, v8
    v_lshrrev_b32 v10, 16, v10
    v_mul_u32_u24 v12, 22, v10
    v_sub_u32 v12, v8, v12
    s_lshl_b32 s23, s18, 5
    v_add_u32 v10, s23, v10
    v_mul_u32_u24 v13, 368, v10
    v_lshl_add_u32 v13, v12, 4, v13
    v_add_u32 v13, 0x10000, v13
    ds_read_b128 v[56:59], v13
    s_lshl_b32 s23, s16, 7
    v_add_u32 v10, s23, v10
    v_lshlrev_b32 v10, 12, v10
    v_lshl_add_u32 v10, v12, 4, v10
    v_add_u32 v120, s22, v10
    v_add_u32 v8, 576, v2
    v_mul_u32_u24 v10, 2979, v8
    v_lshrrev_b32 v10, 16, v10
    v_mul_u32_u24 v12, 22, v10
    v_sub_u32 v12, v8, v12
    s_lshl_b32 s23, s18, 5
    v_add_u32 v10, s23, v10
    v_mul_u32_u24 v13, 368, v10
    v_lshl_add_u32 v13, v12, 4, v13
    v_add_u32 v13, 0x10000, v13
    ds_read_b128 v[60:63], v13
    s_lshl_b32 s23, s16, 7
    v_add_u32 v10, s23, v10
    v_lshlrev_b32 v10, 12, v10
    v_lshl_add_u32 v10, v12, 4, v10
    v_add_u32 v121, s22, v10
    v_add_u32 v8, 640, v2
    v_mul_u32_u24 v10, 2979, v8
    v_lshrrev_b32 v10, 16, v10
    v_mul_u32_u24 v12, 22, v10
    v_sub_u32 v12, v8, v12
    s_lshl_b32 s23, s18, 5
    v_add_u32 v10, s23, v10
    v_mul_u32_u24 v13, 368, v10
    v_lshl_add_u32 v13, v12, 4, v13
    v_add_u32 v13, 0x10000, v13
    ds_read_b128 v[64:67], v13
    s_lshl_b32 s23, s16, 7
    v_add_u32 v10, s23, v10
    v_lshlrev_b32 v10, 12, v10
    v_lshl_add_u32 v10, v12, 4, v10
    v_add_u32 v122, s22, v10
    s_waitcnt lgkmcnt(10)
    buffer_store_dwordx4 v[24:27], v112, s[12:15], 0 offen
    s_waitcnt lgkmcnt(9)
    buffer_store_dwordx4 v[28:31], v113, s[12:15], 0 offen
    s_waitcnt lgkmcnt(8)
    buffer_store_dwordx4 v[32:35], v114, s[12:15], 0 offen
    s_waitcnt lgkmcnt(7)
    buffer_store_dwordx4 v[36:39], v115, s[12:15], 0 offen
    s_waitcnt lgkmcnt(6)
    buffer_store_dwordx4 v[40:43], v116, s[12:15], 0 offen
    s_waitcnt lgkmcnt(5)
    buffer_store_dwordx4 v[44:47], v117, s[12:15], 0 offen
    s_waitcnt lgkmcnt(4)
    buffer_store_dwordx4 v[48:51], v118, s[12:15], 0 offen
    s_waitcnt lgkmcnt(3)
    buffer_store_dwordx4 v[52:55], v119, s[12:15], 0 offen
    s_waitcnt lgkmcnt(2)
    buffer_store_dwordx4 v[56:59], v120, s[12:15], 0 offen
    s_waitcnt lgkmcnt(1)
    buffer_store_dwordx4 v[60:63], v121, s[12:15], 0 offen
    s_waitcnt lgkmcnt(0)
    buffer_store_dwordx4 v[64:67], v122, s[12:15], 0 offen
    s_waitcnt vmcnt(0)
    s_endpgm
g1_done:
    s_endpgm
.section .rodata,"a"
.p2align 6
.amdhsa_kernel gemm1_kernel
  .amdhsa_next_free_vgpr 224
  .amdhsa_next_free_sgpr 102
  .amdhsa_accum_offset 224
  .amdhsa_group_segment_fixed_size 0
  .amdhsa_kernarg_size 104
  .amdhsa_user_sgpr_count 2
  .amdhsa_user_sgpr_kernarg_segment_ptr 1
  .amdhsa_system_sgpr_workgroup_id_x 1
.end_amdhsa_kernel
.text
.globl gemm2_kernel
.p2align 8
.type gemm2_kernel,@function
gemm2_kernel:
    s_cmp_ge_u32 s2, 256
    s_cbranch_scc1 g2_done
    s_load_dwordx2 s[6:7], s[0:1], 96
    s_load_dwordx2 s[40:41], s[0:1], 8
    s_load_dwordx2 s[42:43], s[0:1], 16
    s_load_dwordx2 s[54:55], s[0:1], 88
    s_load_dwordx2 s[56:57], s[0:1], 0
    s_load_dwordx2 s[58:59], s[0:1], 72
    s_load_dwordx2 s[60:61], s[0:1], 80
    s_and_b32 s3, s2, 7
    s_lshr_b32 s4, s2, 3
    s_and_b32 s17, s4, 3
    s_lshr_b32 s4, s4, 2
    s_lshl_b32 s3, s3, 3
    s_add_u32 s3, s3, s4
    s_and_b32 s16, s3, 15
    s_lshr_b32 s19, s3, 4
    v_lshrrev_b32 v1, 6, v0
    v_and_b32 v2, 63, v0
    s_nop 0
    v_readfirstlane_b32 s18, v1
    s_waitcnt lgkmcnt(0)
    s_lshr_b32 s52, s18, 2
    s_and_b32 s18, s18, 3
    s_add_u32 s44, s6, 0xb00000
    s_addc_u32 s45, s7, 0
    s_add_u32 s46, s6, 0x700000
    s_addc_u32 s47, s7, 0
    s_add_u32 s48, s6, 0x900000
    s_addc_u32 s49, s7, 0
    s_add_u32 s50, s6, 0x500000
    s_addc_u32 s51, s7, 0
    s_and_b32 s41, s41, 0xffff
    s_and_b32 s43, s43, 0xffff
    s_and_b32 s45, s45, 0xffff
    s_and_b32 s47, s47, 0xffff
    s_and_b32 s49, s49, 0xffff
    s_and_b32 s51, s51, 0xffff
    s_mul_i32 s26, s19, 23
    s_add_u32 s34, s26, 23
    s_mov_b32 s8, s40
    s_mov_b32 s9, s41
    s_mov_b32 s12, s46
    s_mov_b32 s13, s47
    s_mov_b32 s35, s26
    s_cmp_lt_u32 s26, 32
    s_cbranch_scc1 g2_seg_ok
    s_mov_b32 s8, s42
    s_mov_b32 s9, s43
    s_mov_b32 s12, s48
    s_mov_b32 s13, s49
    s_sub_u32 s35, s26, 32
    s_cmp_lt_u32 s26, 64
    s_cbranch_scc1 g2_seg_ok
    s_mov_b32 s8, s44
    s_mov_b32 s9, s45
    s_mov_b32 s12, s50
    s_mov_b32 s13, s51
    s_sub_u32 s35, s26, 64
g2_seg_ok:
    s_mov_b32 s10, 0x800000
    s_mov_b32 s11, 0x20000
    s_mov_b32 s14, 0x200000
    s_mov_b32 s15, 0x20000
    v_lshrrev_b32 v3, 3, v2
    v_and_b32 v4, 7, v2
    v_lshrrev_b32 v5, 4, v2
    s_and_b32 s20, s18, 1
    s_lshl_b32 s20, s20, 2
    v_add_u32 v5, s20, v5
    v_xor_b32 v4, v4, v5
    v_lshlrev_b32 v4, 4, v4
    v_lshl_add_u32 v3, v3, 12, v4
    s_lshl_b32 s21, s18, 3
    s_lshl_b32 s20, s16, 7
    s_add_u32 s20, s20, s21
    s_lshl_b32 s20, s20, 12
    v_add_u32 v10, s20, v3
    v_add_u32 v11, 0x20000, v10
    v_add_u32 v12, 0x40000, v10
    v_add_u32 v13, 0x60000, v10
    s_lshl_b32 s20, s17, 7
    s_add_u32 s20, s20, s21
    s_lshl_b32 s20, s20, 12
    v_add_u32 v14, s20, v3
    v_add_u32 v15, 0x20000, v14
    v_add_u32 v16, 0x40000, v14
    v_add_u32 v17, 0x60000, v14
    s_lshl_b32 s24, s18, 10
    v_and_b32 v5, 31, v2
    v_lshrrev_b32 v6, 5, v2
    v_lshrrev_b32 v7, 1, v5
    v_and_b32 v7, 7, v7
    v_xor_b32 v6, v6, v7
    v_lshlrev_b32 v6, 4, v6
    v_lshl_add_u32 v6, v5, 7, v6
    s_lshr_b32 s20, s18, 1
    s_and_b32 s21, s18, 1
    s_lshl_b32 s22, s20, 13
    s_lshl_b32 s23, s21, 13
    s_add_u32 s23, s23, 0x4000
    v_add_u32 v20, s22, v6
    v_add_u32 v24, s23, v6
    v_xor_b32 v21, 32, v20
    v_xor_b32 v25, 32, v24
    v_xor_b32 v22, 64, v20
    v_xor_b32 v26, 64, v24
    v_xor_b32 v23, 96, v20
    v_xor_b32 v27, 96, v24
    v_mov_b32 v28, 0
    v_mov_b32 v29, 0
    v_mov_b32 v30, 0
    v_mov_b32 v31, 0
    v_mov_b32 v32, 0
    v_mov_b32 v33, 0
    v_mov_b32 v34, 0
    v_mov_b32 v35, 0
    v_mov_b32 v36, 0
    v_mov_b32 v37, 0
    v_mov_b32 v38, 0
    v_mov_b32 v39, 0
    v_mov_b32 v40, 0
    v_mov_b32 v41, 0
    v_mov_b32 v42, 0
    v_mov_b32 v43, 0
    v_mov_b32 v44, 0
    v_mov_b32 v45, 0
    v_mov_b32 v46, 0
    v_mov_b32 v47, 0
    v_mov_b32 v48, 0
    v_mov_b32 v49, 0
    v_mov_b32 v50, 0
    v_mov_b32 v51, 0
    v_mov_b32 v52, 0
    v_mov_b32 v53, 0
    v_mov_b32 v54, 0
    v_mov_b32 v55, 0
    v_mov_b32 v56, 0
    v_mov_b32 v57, 0
    v_mov_b32 v58, 0
    v_mov_b32 v59, 0
    v_mov_b32 v60, 0
    v_mov_b32 v61, 0
    v_mov_b32 v62, 0
    v_mov_b32 v63, 0
    v_mov_b32 v64, 0
    v_mov_b32 v65, 0
    v_mov_b32 v66, 0
    v_mov_b32 v67, 0
    v_mov_b32 v68, 0
    v_mov_b32 v69, 0
    v_mov_b32 v70, 0
    v_mov_b32 v71, 0
    v_mov_b32 v72, 0
    v_mov_b32 v73, 0
    v_mov_b32 v74, 0
    v_mov_b32 v75, 0
    v_mov_b32 v76, 0
    v_mov_b32 v77, 0
    v_mov_b32 v78, 0
    v_mov_b32 v79, 0
    v_mov_b32 v80, 0
    v_mov_b32 v81, 0
    v_mov_b32 v82, 0
    v_mov_b32 v83, 0
    v_mov_b32 v84, 0
    v_mov_b32 v85, 0
    v_mov_b32 v86, 0
    v_mov_b32 v87, 0
    v_mov_b32 v88, 0
    v_mov_b32 v89, 0
    v_mov_b32 v90, 0
    v_mov_b32 v91, 0
    s_mov_b32 s27, 0
    s_cmp_eq_u32 s52, 0
    s_cbranch_scc1 g2_compute
    s_lshl_b32 s29, s35, 7
    s_cmp_ge_u32 s26, s34
    s_cselect_b32 s29, 0x80000000, s29
    s_add_u32 s30, s27, s24
    s_add_u32 m0, s30, 0
    s_nop 0
    buffer_load_dwordx4 v10, s[8:11], s29 offen lds
    s_add_u32 m0, s30, 4096
    s_nop 0
    buffer_load_dwordx4 v11, s[8:11], s29 offen lds
    s_add_u32 m0, s30, 8192
    s_nop 0
    buffer_load_dwordx4 v12, s[8:11], s29 offen lds
    s_add_u32 m0, s30, 12288
    s_nop 0
    buffer_load_dwordx4 v13, s[8:11], s29 offen lds
    s_add_u32 m0, s30, 16384
    s_nop 0
    buffer_load_dwordx4 v14, s[12:15], s29 offen lds
    s_add_u32 m0, s30, 20480
    s_nop 0
    buffer_load_dwordx4 v15, s[12:15], s29 offen lds
    s_add_u32 m0, s30, 24576
    s_nop 0
    buffer_load_dwordx4 v16, s[12:15], s29 offen lds
    s_add_u32 m0, s30, 28672
    s_nop 0
    buffer_load_dwordx4 v17, s[12:15], s29 offen lds
    s_add_u32 s26, s26, 1
    s_add_u32 s35, s35, 1
    s_add_u32 s27, s27, 32768
    s_and_b32 s27, s27, 0x1ffff
    s_cmp_lg_u32 s26, 32
    s_cbranch_scc1 g2_sw1_1
    s_mov_b32 s8, s42
    s_mov_b32 s9, s43
    s_mov_b32 s12, s48
    s_mov_b32 s13, s49
    s_mov_b32 s35, 0
g2_sw1_1:
    s_cmp_lg_u32 s26, 64
    s_cbranch_scc1 g2_sw2_1
    s_mov_b32 s8, s44
    s_mov_b32 s9, s45
    s_mov_b32 s12, s50
    s_mov_b32 s13, s51
    s_mov_b32 s35, 0
g2_sw2_1:
    s_lshl_b32 s29, s35, 7
    s_cmp_ge_u32 s26, s34
    s_cselect_b32 s29, 0x80000000, s29
    s_add_u32 s30, s27, s24
    s_add_u32 m0, s30, 0
    s_nop 0
    buffer_load_dwordx4 v10, s[8:11], s29 offen lds
    s_add_u32 m0, s30, 4096
    s_nop 0
    buffer_load_dwordx4 v11, s[8:11], s29 offen lds
    s_add_u32 m0, s30, 8192
    s_nop 0
    buffer_load_dwordx4 v12, s[8:11], s29 offen lds
    s_add_u32 m0, s30, 12288
    s_nop 0
    buffer_load_dwordx4 v13, s[8:11], s29 offen lds
    s_add_u32 m0, s30, 16384
    s_nop 0
    buffer_load_dwordx4 v14, s[12:15], s29 offen lds
    s_add_u32 m0, s30, 20480
    s_nop 0
    buffer_load_dwordx4 v15, s[12:15], s29 offen lds
    s_add_u32 m0, s30, 24576
    s_nop 0
    buffer_load_dwordx4 v16, s[12:15], s29 offen lds
    s_add_u32 m0, s30, 28672
    s_nop 0
    buffer_load_dwordx4 v17, s[12:15], s29 offen lds
    s_add_u32 s26, s26, 1
    s_add_u32 s35, s35, 1
    s_add_u32 s27, s27, 32768
    s_and_b32 s27, s27, 0x1ffff
    s_cmp_lg_u32 s26, 32
    s_cbranch_scc1 g2_sw1_2
    s_mov_b32 s8, s42
    s_mov_b32 s9, s43
    s_mov_b32 s12, s48
    s_mov_b32 s13, s49
    s_mov_b32 s35, 0
g2_sw1_2:
    s_cmp_lg_u32 s26, 64
    s_cbranch_scc1 g2_sw2_2
    s_mov_b32 s8, s44
    s_mov_b32 s9, s45
    s_mov_b32 s12, s50
    s_mov_b32 s13, s51
    s_mov_b32 s35, 0
g2_sw2_2:
    s_lshl_b32 s29, s35, 7
    s_cmp_ge_u32 s26, s34
    s_cselect_b32 s29, 0x80000000, s29
    s_add_u32 s30, s27, s24
    s_add_u32 m0, s30, 0
    s_nop 0
    buffer_load_dwordx4 v10, s[8:11], s29 offen lds
    s_add_u32 m0, s30, 4096
    s_nop 0
    buffer_load_dwordx4 v11, s[8:11], s29 offen lds
    s_add_u32 m0, s30, 8192
    s_nop 0
    buffer_load_dwordx4 v12, s[8:11], s29 offen lds
    s_add_u32 m0, s30, 12288
    s_nop 0
    buffer_load_dwordx4 v13, s[8:11], s29 offen lds
    s_add_u32 m0, s30, 16384
    s_nop 0
    buffer_load_dwordx4 v14, s[12:15], s29 offen lds
    s_add_u32 m0, s30, 20480
    s_nop 0
    buffer_load_dwordx4 v15, s[12:15], s29 offen lds
    s_add_u32 m0, s30, 24576
    s_nop 0
    buffer_load_dwordx4 v16, s[12:15], s29 offen lds
    s_add_u32 m0, s30, 28672
    s_nop 0
    buffer_load_dwordx4 v17, s[12:15], s29 offen lds
    s_add_u32 s26, s26, 1
    s_add_u32 s35, s35, 1
    s_add_u32 s27, s27, 32768
    s_and_b32 s27, s27, 0x1ffff
    s_cmp_lg_u32 s26, 32
    s_cbranch_scc1 g2_sw1_3
    s_mov_b32 s8, s42
    s_mov_b32 s9, s43
    s_mov_b32 s12, s48
    s_mov_b32 s13, s49
    s_mov_b32 s35, 0
g2_sw1_3:
    s_cmp_lg_u32 s26, 64
    s_cbranch_scc1 g2_sw2_3
    s_mov_b32 s8, s44
    s_mov_b32 s9, s45
    s_mov_b32 s12, s50
    s_mov_b32 s13, s51
    s_mov_b32 s35, 0
g2_sw2_3:
    s_waitcnt vmcnt(16)
    s_barrier
    s_mov_b32 s32, 0
g2_load_loop:
    s_waitcnt vmcnt(8)
    s_barrier
    s_lshl_b32 s29, s35, 7
    s_cmp_ge_u32 s26, s34
    s_cselect_b32 s29, 0x80000000, s29
    s_add_u32 s30, s27, s24
    s_add_u32 m0, s30, 0
    s_nop 0
    buffer_load_dwordx4 v10, s[8:11], s29 offen lds
    s_add_u32 m0, s30, 4096
    s_nop 0
    buffer_load_dwordx4 v11, s[8:11], s29 offen lds
    s_add_u32 m0, s30, 8192
    s_nop 0
    buffer_load_dwordx4 v12, s[8:11], s29 offen lds
    s_add_u32 m0, s30, 12288
    s_nop 0
    buffer_load_dwordx4 v13, s[8:11], s29 offen lds
    s_add_u32 m0, s30, 16384
    s_nop 0
    buffer_load_dwordx4 v14, s[12:15], s29 offen lds
    s_add_u32 m0, s30, 20480
    s_nop 0
    buffer_load_dwordx4 v15, s[12:15], s29 offen lds
    s_add_u32 m0, s30, 24576
    s_nop 0
    buffer_load_dwordx4 v16, s[12:15], s29 offen lds
    s_add_u32 m0, s30, 28672
    s_nop 0
    buffer_load_dwordx4 v17, s[12:15], s29 offen lds
    s_add_u32 s26, s26, 1
    s_add_u32 s35, s35, 1
    s_add_u32 s27, s27, 32768
    s_and_b32 s27, s27, 0x1ffff
    s_cmp_lg_u32 s26, 32
    s_cbranch_scc1 g2_sw1_4
    s_mov_b32 s8, s42
    s_mov_b32 s9, s43
    s_mov_b32 s12, s48
    s_mov_b32 s13, s49
    s_mov_b32 s35, 0
g2_sw1_4:
    s_cmp_lg_u32 s26, 64
    s_cbranch_scc1 g2_sw2_4
    s_mov_b32 s8, s44
    s_mov_b32 s9, s45
    s_mov_b32 s12, s50
    s_mov_b32 s13, s51
    s_mov_b32 s35, 0
g2_sw2_4:
    s_add_u32 s32, s32, 1
    s_cmp_lt_u32 s32, 23
    s_cbranch_scc1 g2_load_loop
    s_endpgm
g2_compute:
    s_add_u32 s64, s6, 0x1f00000
    s_addc_u32 s65, s7, 0
    s_and_b32 s65, s65, 0xffff
    s_mov_b32 s66, 0x8000
    s_mov_b32 s67, 0x20000
    s_mov_b32 s68, s56
    s_mov_b32 s69, s57
    s_and_b32 s69, s69, 0xffff
    s_mov_b32 s70, 0x200000
    s_mov_b32 s71, 0x20000
    s_mov_b32 s72, s58
    s_mov_b32 s73, s59
    s_and_b32 s73, s73, 0xffff
    s_mov_b32 s74, 0x400
    s_mov_b32 s75, 0x20000
    s_mov_b32 s76, s60
    s_mov_b32 s77, s61
    s_and_b32 s77, s77, 0xffff
    s_mov_b32 s78, 0x200000
    s_mov_b32 s79, 0x20000
    s_lshl_b32 s22, s16, 2
    s_add_u32 s22, s22, s17
    s_lshl_b32 s62, s22, 2
    s_add_u32 s62, s62, s18
    s_lshl_b32 s62, s62, 7
    s_lshl_b32 s25, s22, 18
    s_add_u32 s25, s25, 0x2000000
    s_add_u32 s80, s6, s25
    s_addc_u32 s81, s7, 0
    s_and_b32 s81, s81, 0xffff
    s_mov_b32 s82, 0x40000
    s_mov_b32 s83, 0x20000
    s_lshr_b32 s27, s19, 1
    s_and_b32 s24, s19, 1
    v_and_b32 v6, 31, v2
    v_lshrrev_b32 v7, 5, v2
    s_lshl_b32 s22, s16, 7
    s_lshl_b32 s25, s20, 6
    s_add_u32 s22, s22, s25
    s_lshl_b32 s25, s27, 5
    s_add_u32 s22, s22, s25
    s_lshl_b32 s25, s17, 7
    s_lshl_b32 s27, s21, 6
    s_add_u32 s25, s25, s27
    s_lshl_b32 s27, s24, 5
    s_add_u32 s25, s25, s27
    v_add_u32 v6, s22, v6
    v_lshlrev_b32 v6, 10, v6
    v_lshlrev_b32 v7, 3, v7
    s_lshl_b32 s25, s25, 1
    v_add_u32 v7, s25, v7
    v_add_u32 v6, v6, v7
    buffer_load_dwordx2 v[192:193], v6, s[68:71], 0 offen offset:0
    buffer_load_dwordx2 v[200:201], v7, s[72:75], 0 offen offset:0
    buffer_load_dwordx2 v[194:195], v6, s[68:71], 0 offen offset:16
    buffer_load_dwordx2 v[202:203], v7, s[72:75], 0 offen offset:16
    buffer_load_dwordx2 v[196:197], v6, s[68:71], 0 offen offset:32
    buffer_load_dwordx2 v[204:205], v7, s[72:75], 0 offen offset:32
    buffer_load_dwordx2 v[198:199], v6, s[68:71], 0 offen offset:48
    buffer_load_dwordx2 v[206:207], v7, s[72:75], 0 offen offset:48
    s_barrier
    ds_read_b128 v[92:95], v20
    ds_read_b128 v[96:99], v20 offset:4096
    ds_read_b128 v[100:103], v24
    ds_read_b128 v[104:107], v24 offset:4096
    s_mov_b32 s32, 0
g2_loop:
    ds_read_b128 v[108:111], v21
    ds_read_b128 v[112:115], v21 offset:4096
    ds_read_b128 v[116:119], v25
    ds_read_b128 v[120:123], v25 offset:4096
    s_waitcnt lgkmcnt(4)
    v_mfma_f32_32x32x16_bf16 v[28:43], v[100:103], v[92:95], v[28:43]
    v_mfma_f32_32x32x16_bf16 v[44:59], v[104:107], v[92:95], v[44:59]
    v_mfma_f32_32x32x16_bf16 v[60:75], v[100:103], v[96:99], v[60:75]
    v_mfma_f32_32x32x16_bf16 v[76:91], v[104:107], v[96:99], v[76:91]
    ds_read_b128 v[92:95], v22
    ds_read_b128 v[96:99], v22 offset:4096
    ds_read_b128 v[100:103], v26
    ds_read_b128 v[104:107], v26 offset:4096
    s_waitcnt lgkmcnt(4)
    v_mfma_f32_32x32x16_bf16 v[28:43], v[116:119], v[108:111], v[28:43]
    v_mfma_f32_32x32x16_bf16 v[44:59], v[120:123], v[108:111], v[44:59]
    v_mfma_f32_32x32x16_bf16 v[60:75], v[116:119], v[112:115], v[60:75]
    v_mfma_f32_32x32x16_bf16 v[76:91], v[120:123], v[112:115], v[76:91]
    ds_read_b128 v[108:111], v23
    ds_read_b128 v[112:115], v23 offset:4096
    ds_read_b128 v[116:119], v27
    ds_read_b128 v[120:123], v27 offset:4096
    s_waitcnt lgkmcnt(4)
    v_mfma_f32_32x32x16_bf16 v[28:43], v[100:103], v[92:95], v[28:43]
    v_mfma_f32_32x32x16_bf16 v[44:59], v[104:107], v[92:95], v[44:59]
    v_mfma_f32_32x32x16_bf16 v[60:75], v[100:103], v[96:99], v[60:75]
    v_mfma_f32_32x32x16_bf16 v[76:91], v[104:107], v[96:99], v[76:91]
    s_barrier
    v_add_u32 v20, 32768, v20
    v_and_b32 v20, 0x1ffff, v20
    v_add_u32 v21, 32768, v21
    v_and_b32 v21, 0x1ffff, v21
    v_add_u32 v22, 32768, v22
    v_and_b32 v22, 0x1ffff, v22
    v_add_u32 v23, 32768, v23
    v_and_b32 v23, 0x1ffff, v23
    v_add_u32 v24, 32768, v24
    v_and_b32 v24, 0x1ffff, v24
    v_add_u32 v25, 32768, v25
    v_and_b32 v25, 0x1ffff, v25
    v_add_u32 v26, 32768, v26
    v_and_b32 v26, 0x1ffff, v26
    v_add_u32 v27, 32768, v27
    v_and_b32 v27, 0x1ffff, v27
    ds_read_b128 v[92:95], v20
    ds_read_b128 v[96:99], v20 offset:4096
    ds_read_b128 v[100:103], v24
    ds_read_b128 v[104:107], v24 offset:4096
    s_waitcnt lgkmcnt(4)
    v_mfma_f32_32x32x16_bf16 v[28:43], v[116:119], v[108:111], v[28:43]
    v_mfma_f32_32x32x16_bf16 v[44:59], v[120:123], v[108:111], v[44:59]
    v_mfma_f32_32x32x16_bf16 v[60:75], v[116:119], v[112:115], v[60:75]
    v_mfma_f32_32x32x16_bf16 v[76:91], v[120:123], v[112:115], v[76:91]
    s_add_u32 s32, s32, 1
    s_cmp_lt_u32 s32, 23
    s_cbranch_scc1 g2_loop
    s_waitcnt lgkmcnt(0)
    s_nop 7
    s_nop 7
    s_lshl_b32 s25, s18, 12
    v_lshlrev_b32 v5, 4, v2
    v_add_u32 v5, s25, v5
    s_lshl_b32 s26, s19, 14
    s_cmp_eq_u32 s19, 0
    s_cbranch_scc1 g2_own_0
    s_add_u32 s25, s26, 0x0
    buffer_store_dwordx4 v[28:31], v5, s[80:83], s25 offen offset:0 sc1
    buffer_store_dwordx4 v[32:35], v5, s[80:83], s25 offen offset:1024 sc1
    buffer_store_dwordx4 v[36:39], v5, s[80:83], s25 offen offset:2048 sc1
    buffer_store_dwordx4 v[40:43], v5, s[80:83], s25 offen offset:3072 sc1
    s_branch g2_st_0
g2_own_0:
    v_mov_b32 v92, v28
    v_mov_b32 v93, v29
    v_mov_b32 v94, v30
    v_mov_b32 v95, v31
    v_mov_b32 v96, v32
    v_mov_b32 v97, v33
    v_mov_b32 v98, v34
    v_mov_b32 v99, v35
    v_mov_b32 v100, v36
    v_mov_b32 v101, v37
    v_mov_b32 v102, v38
    v_mov_b32 v103, v39
    v_mov_b32 v104, v40
    v_mov_b32 v105, v41
    v_mov_b32 v106, v42
    v_mov_b32 v107, v43
g2_st_0:
    s_cmp_eq_u32 s19, 1
    s_cbranch_scc1 g2_own_1
    s_add_u32 s25, s26, 0x10000
    buffer_store_dwordx4 v[44:47], v5, s[80:83], s25 offen offset:0 sc1
    buffer_store_dwordx4 v[48:51], v5, s[80:83], s25 offen offset:1024 sc1
    buffer_store_dwordx4 v[52:55], v5, s[80:83], s25 offen offset:2048 sc1
    buffer_store_dwordx4 v[56:59], v5, s[80:83], s25 offen offset:3072 sc1
    s_branch g2_st_1
g2_own_1:
    v_mov_b32 v92, v44
    v_mov_b32 v93, v45
    v_mov_b32 v94, v46
    v_mov_b32 v95, v47
    v_mov_b32 v96, v48
    v_mov_b32 v97, v49
    v_mov_b32 v98, v50
    v_mov_b32 v99, v51
    v_mov_b32 v100, v52
    v_mov_b32 v101, v53
    v_mov_b32 v102, v54
    v_mov_b32 v103, v55
    v_mov_b32 v104, v56
    v_mov_b32 v105, v57
    v_mov_b32 v106, v58
    v_mov_b32 v107, v59
g2_st_1:
    s_cmp_eq_u32 s19, 2
    s_cbranch_scc1 g2_own_2
    s_add_u32 s25, s26, 0x20000
    buffer_store_dwordx4 v[60:63], v5, s[80:83], s25 offen offset:0 sc1
    buffer_store_dwordx4 v[64:67], v5, s[80:83], s25 offen offset:1024 sc1
    buffer_store_dwordx4 v[68:71], v5, s[80:83], s25 offen offset:2048 sc1
    buffer_store_dwordx4 v[72:75], v5, s[80:83], s25 offen offset:3072 sc1
    s_branch g2_st_2
g2_own_2:
    v_mov_b32 v92, v60
    v_mov_b32 v93, v61
    v_mov_b32 v94, v62
    v_mov_b32 v95, v63
    v_mov_b32 v96, v64
    v_mov_b32 v97, v65
    v_mov_b32 v98, v66
    v_mov_b32 v99, v67
    v_mov_b32 v100, v68
    v_mov_b32 v101, v69
    v_mov_b32 v102, v70
    v_mov_b32 v103, v71
    v_mov_b32 v104, v72
    v_mov_b32 v105, v73
    v_mov_b32 v106, v74
    v_mov_b32 v107, v75
g2_st_2:
    s_cmp_eq_u32 s19, 3
    s_cbranch_scc1 g2_own_3
    s_add_u32 s25, s26, 0x30000
    buffer_store_dwordx4 v[76:79], v5, s[80:83], s25 offen offset:0 sc1
    buffer_store_dwordx4 v[80:83], v5, s[80:83], s25 offen offset:1024 sc1
    buffer_store_dwordx4 v[84:87], v5, s[80:83], s25 offen offset:2048 sc1
    buffer_store_dwordx4 v[88:91], v5, s[80:83], s25 offen offset:3072 sc1
    s_branch g2_st_3
g2_own_3:
    v_mov_b32 v92, v76
    v_mov_b32 v93, v77
    v_mov_b32 v94, v78
    v_mov_b32 v95, v79
    v_mov_b32 v96, v80
    v_mov_b32 v97, v81
    v_mov_b32 v98, v82
    v_mov_b32 v99, v83
    v_mov_b32 v100, v84
    v_mov_b32 v101, v85
    v_mov_b32 v102, v86
    v_mov_b32 v103, v87
    v_mov_b32 v104, v88
    v_mov_b32 v105, v89
    v_mov_b32 v106, v90
    v_mov_b32 v107, v91
g2_st_3:
    v_mov_b32 v1, s62
    s_lshl_b32 s24, s19, 2
    v_add_u32 v4, s24, v1
    v_mov_b32 v3, 1
    s_mov_b64 s[48:49], exec
    s_waitcnt vmcnt(0)
    s_mov_b64 exec, 1
    buffer_store_dword v3, v4, s[64:67], 0 offen sc1
g2_poll:
    buffer_load_dwordx4 v[8:11], v1, s[64:67], 0 offen sc1
    s_waitcnt vmcnt(0)
    v_add_u32 v8, v8, v9
    v_add_u32 v10, v10, v11
    v_add_u32 v8, v8, v10
    s_nop 0
    v_readfirstlane_b32 s25, v8
    s_nop 1
    s_cmp_ge_u32 s25, 4
    s_cbranch_scc1 g2_poll_x
    s_sleep 2
    s_branch g2_poll
g2_poll_x:
    s_mov_b64 exec, s[48:49]
    s_lshl_b32 s26, s19, 16
    s_add_u32 s25, s26, 0x0
    s_cmp_eq_u32 s19, 0
    s_cselect_b32 s25, 0x80000000, s25
    buffer_load_dwordx4 v[128:131], v5, s[80:83], s25 offen offset:0 sc1
    buffer_load_dwordx4 v[132:135], v5, s[80:83], s25 offen offset:1024 sc1
    buffer_load_dwordx4 v[136:139], v5, s[80:83], s25 offen offset:2048 sc1
    buffer_load_dwordx4 v[140:143], v5, s[80:83], s25 offen offset:3072 sc1
    s_add_u32 s25, s26, 0x4000
    s_cmp_eq_u32 s19, 1
    s_cselect_b32 s25, 0x80000000, s25
    buffer_load_dwordx4 v[144:147], v5, s[80:83], s25 offen offset:0 sc1
    buffer_load_dwordx4 v[148:151], v5, s[80:83], s25 offen offset:1024 sc1
    buffer_load_dwordx4 v[152:155], v5, s[80:83], s25 offen offset:2048 sc1
    buffer_load_dwordx4 v[156:159], v5, s[80:83], s25 offen offset:3072 sc1
    s_add_u32 s25, s26, 0x8000
    s_cmp_eq_u32 s19, 2
    s_cselect_b32 s25, 0x80000000, s25
    buffer_load_dwordx4 v[160:163], v5, s[80:83], s25 offen offset:0 sc1
    buffer_load_dwordx4 v[164:167], v5, s[80:83], s25 offen offset:1024 sc1
    buffer_load_dwordx4 v[168:171], v5, s[80:83], s25 offen offset:2048 sc1
    buffer_load_dwordx4 v[172:175], v5, s[80:83], s25 offen offset:3072 sc1
    s_add_u32 s25, s26, 0xc000
    s_cmp_eq_u32 s19, 3
    s_cselect_b32 s25, 0x80000000, s25
    buffer_load_dwordx4 v[176:179], v5, s[80:83], s25 offen offset:0 sc1
    buffer_load_dwordx4 v[180:183], v5, s[80:83], s25 offen offset:1024 sc1
    buffer_load_dwordx4 v[184:187], v5, s[80:83], s25 offen offset:2048 sc1
    buffer_load_dwordx4 v[188:191], v5, s[80:83], s25 offen offset:3072 sc1
    s_waitcnt vmcnt(0)
    v_add_f32 v128, v128, v144
    v_add_f32 v160, v160, v176
    v_add_f32 v92, v92, v128
    v_add_f32 v92, v92, v160
    v_add_f32 v129, v129, v145
    v_add_f32 v161, v161, v177
    v_add_f32 v93, v93, v129
    v_add_f32 v93, v93, v161
    v_add_f32 v130, v130, v146
    v_add_f32 v162, v162, v178
    v_add_f32 v94, v94, v130
    v_add_f32 v94, v94, v162
    v_add_f32 v131, v131, v147
    v_add_f32 v163, v163, v179
    v_add_f32 v95, v95, v131
    v_add_f32 v95, v95, v163
    v_add_f32 v132, v132, v148
    v_add_f32 v164, v164, v180
    v_add_f32 v96, v96, v132
    v_add_f32 v96, v96, v164
    v_add_f32 v133, v133, v149
    v_add_f32 v165, v165, v181
    v_add_f32 v97, v97, v133
    v_add_f32 v97, v97, v165
    v_add_f32 v134, v134, v150
    v_add_f32 v166, v166, v182
    v_add_f32 v98, v98, v134
    v_add_f32 v98, v98, v166
    v_add_f32 v135, v135, v151
    v_add_f32 v167, v167, v183
    v_add_f32 v99, v99, v135
    v_add_f32 v99, v99, v167
    v_add_f32 v136, v136, v152
    v_add_f32 v168, v168, v184
    v_add_f32 v100, v100, v136
    v_add_f32 v100, v100, v168
    v_add_f32 v137, v137, v153
    v_add_f32 v169, v169, v185
    v_add_f32 v101, v101, v137
    v_add_f32 v101, v101, v169
    v_add_f32 v138, v138, v154
    v_add_f32 v170, v170, v186
    v_add_f32 v102, v102, v138
    v_add_f32 v102, v102, v170
    v_add_f32 v139, v139, v155
    v_add_f32 v171, v171, v187
    v_add_f32 v103, v103, v139
    v_add_f32 v103, v103, v171
    v_add_f32 v140, v140, v156
    v_add_f32 v172, v172, v188
    v_add_f32 v104, v104, v140
    v_add_f32 v104, v104, v172
    v_add_f32 v141, v141, v157
    v_add_f32 v173, v173, v189
    v_add_f32 v105, v105, v141
    v_add_f32 v105, v105, v173
    v_add_f32 v142, v142, v158
    v_add_f32 v174, v174, v190
    v_add_f32 v106, v106, v142
    v_add_f32 v106, v106, v174
    v_add_f32 v143, v143, v159
    v_add_f32 v175, v175, v191
    v_add_f32 v107, v107, v143
    v_add_f32 v107, v107, v175
    v_lshlrev_b32 v8, 16, v192
    v_and_b32 v9, 0xffff0000, v192
    v_add_f32 v92, v92, v8
    v_add_f32 v93, v93, v9
    v_lshlrev_b32 v8, 16, v200
    v_and_b32 v9, 0xffff0000, v200
    v_add_f32 v92, v92, v8
    v_add_f32 v93, v93, v9
    v_lshlrev_b32 v8, 16, v193
    v_and_b32 v9, 0xffff0000, v193
    v_add_f32 v94, v94, v8
    v_add_f32 v95, v95, v9
    v_lshlrev_b32 v8, 16, v201
    v_and_b32 v9, 0xffff0000, v201
    v_add_f32 v94, v94, v8
    v_add_f32 v95, v95, v9
    v_cvt_pk_bf16_f32 v92, v92, v93
    v_cvt_pk_bf16_f32 v93, v94, v95
    buffer_store_dwordx2 v[92:93], v6, s[76:79], 0 offen offset:0
    v_lshlrev_b32 v8, 16, v194
    v_and_b32 v9, 0xffff0000, v194
    v_add_f32 v96, v96, v8
    v_add_f32 v97, v97, v9
    v_lshlrev_b32 v8, 16, v202
    v_and_b32 v9, 0xffff0000, v202
    v_add_f32 v96, v96, v8
    v_add_f32 v97, v97, v9
    v_lshlrev_b32 v8, 16, v195
    v_and_b32 v9, 0xffff0000, v195
    v_add_f32 v98, v98, v8
    v_add_f32 v99, v99, v9
    v_lshlrev_b32 v8, 16, v203
    v_and_b32 v9, 0xffff0000, v203
    v_add_f32 v98, v98, v8
    v_add_f32 v99, v99, v9
    v_cvt_pk_bf16_f32 v96, v96, v97
    v_cvt_pk_bf16_f32 v97, v98, v99
    buffer_store_dwordx2 v[96:97], v6, s[76:79], 0 offen offset:16
    v_lshlrev_b32 v8, 16, v196
    v_and_b32 v9, 0xffff0000, v196
    v_add_f32 v100, v100, v8
    v_add_f32 v101, v101, v9
    v_lshlrev_b32 v8, 16, v204
    v_and_b32 v9, 0xffff0000, v204
    v_add_f32 v100, v100, v8
    v_add_f32 v101, v101, v9
    v_lshlrev_b32 v8, 16, v197
    v_and_b32 v9, 0xffff0000, v197
    v_add_f32 v102, v102, v8
    v_add_f32 v103, v103, v9
    v_lshlrev_b32 v8, 16, v205
    v_and_b32 v9, 0xffff0000, v205
    v_add_f32 v102, v102, v8
    v_add_f32 v103, v103, v9
    v_cvt_pk_bf16_f32 v100, v100, v101
    v_cvt_pk_bf16_f32 v101, v102, v103
    buffer_store_dwordx2 v[100:101], v6, s[76:79], 0 offen offset:32
    v_lshlrev_b32 v8, 16, v198
    v_and_b32 v9, 0xffff0000, v198
    v_add_f32 v104, v104, v8
    v_add_f32 v105, v105, v9
    v_lshlrev_b32 v8, 16, v206
    v_and_b32 v9, 0xffff0000, v206
    v_add_f32 v104, v104, v8
    v_add_f32 v105, v105, v9
    v_lshlrev_b32 v8, 16, v199
    v_and_b32 v9, 0xffff0000, v199
    v_add_f32 v106, v106, v8
    v_add_f32 v107, v107, v9
    v_lshlrev_b32 v8, 16, v207
    v_and_b32 v9, 0xffff0000, v207
    v_add_f32 v106, v106, v8
    v_add_f32 v107, v107, v9
    v_cvt_pk_bf16_f32 v104, v104, v105
    v_cvt_pk_bf16_f32 v105, v106, v107
    buffer_store_dwordx2 v[104:105], v6, s[76:79], 0 offen offset:48
g2_done:
    s_endpgm
.section .rodata,"a"
.p2align 6
.amdhsa_kernel gemm2_kernel
  .amdhsa_next_free_vgpr 208
  .amdhsa_next_free_sgpr 102
  .amdhsa_accum_offset 208
  .amdhsa_group_segment_fixed_size 0
  .amdhsa_kernarg_size 104
  .amdhsa_user_sgpr_count 2
  .amdhsa_user_sgpr_kernarg_segment_ptr 1
  .amdhsa_system_sgpr_workgroup_id_x 1
.end_amdhsa_kernel
.text
```
